```python
import torch

def _softmax(x, axis=-1):
    return torch.softmax(x, dim=axis)
def _gelu(x):
    return torch.nn.functional.gelu(x, approximate="tanh")
def _silu(x):
    return torch.nn.functional.silu(x)
def _sigmoid(x):
    return torch.sigmoid(x)
def _layernorm(x, axis=-1, eps=1e-5):
    m = x.mean(dim=axis, keepdim=True)
    v = x.var(dim=axis, keepdim=True, unbiased=False)
    return (x - m) / torch.sqrt(v + eps)
def _scatter_add(tgt, idx, src, axis=0):
    return tgt.clone().index_add_(axis, idx, src)
def _segment_sum(src, seg, n):
    out = torch.zeros((n,) + src.shape[1:], dtype=src.dtype)
    return out.index_add_(0, seg, src)
def _pad(x, pw):
    flat = tuple(v for pair in reversed(pw) for v in pair)
    return torch.nn.functional.pad(x, flat)

kernel_name = 'recurrent_scan__sliding_block_cached__swiglu_ffn__decode'

def setup_inputs():

    _w = (lambda a: (lambda t: t.to(torch.bfloat16) if t.is_floating_point() else t)(torch.as_tensor(a)))
    def _A_setup():
        B, Sq, D = 2, 1, 512
        Hq, Hkv, Sk, Dh = 32, 32, 8192, 128
        assert Hq % Hkv == 0, (Hq, Hkv)
        return {
            "x": _w((lambda *s: torch.randn(*s, dtype=torch.bfloat16) * 0.05)(B, Sq, D)),
            "k_cache": _w((lambda *s: torch.randn(*s, dtype=torch.bfloat16) * 1.6)(B, Hkv, Sk, Dh)),
            "v_cache": _w((lambda *s: torch.randn(*s, dtype=torch.bfloat16) * 0.2)(B, Hkv, Sk, Dh)),
            "wq": _w((lambda *s: torch.randn(*s, dtype=torch.bfloat16) * 1.6)(D, Hq * Dh) * (D ** -0.5)),
            "wo": _w((lambda *s: torch.randn(*s, dtype=torch.bfloat16) * 0.2)(Hq * Dh, D) * ((Hq * Dh) ** -0.5)),
        }
    _A_in = _A_setup()

    def _B_setup():
        B, S, D, F = 2, 1, 512, 1376
        return {
            "x": _w((lambda *s: torch.randn(*s, dtype=torch.bfloat16) * 0.05)(B, S, D)),
            "w_gate": _w((lambda *s: torch.randn(*s, dtype=torch.bfloat16) * 0.1)(D, F)),
            "w_up": _w((lambda *s: torch.randn(*s, dtype=torch.bfloat16) * 0.1)(D, F)),
            "w_down": _w((lambda *s: torch.randn(*s, dtype=torch.bfloat16) * 0.1)(F, D)),
        }
    _B_in = _B_setup()

    return {
        "A_x": _A_in["x"],
        "A_k_cache": _A_in["k_cache"],
        "A_v_cache": _A_in["v_cache"],
        "A_wq": _A_in["wq"],
        "A_wo": _A_in["wo"],
        "B_x": _B_in["x"],
        "B_w_gate": _B_in["w_gate"],
        "B_w_up": _B_in["w_up"],
        "B_w_down": _B_in["w_down"],
    }

def reference(A_x, A_k_cache, A_v_cache, A_wq, A_wo, B_x, B_w_gate, B_w_up, B_w_down):
    def _A_ref(x, k_cache, v_cache, wq, wo):
        B, Sq, D = x.shape
        Hq, Dh = 32, 128
        Hkv, Sk = k_cache.shape[1], k_cache.shape[2]
        W = min(4096, max(256, Sk // 4))
        rep = Hq // Hkv
        q = (lambda x, *d: x.permute(*d))((x @ wq).reshape(B, Sq, Hq, Dh), 0, 2, 1, 3)
        k = (lambda x, n, axis: torch.repeat_interleave(x, n, dim=axis))(k_cache[:, :, Sk - W:, :], rep, axis=1)
        v = (lambda x, n, axis: torch.repeat_interleave(x, n, dim=axis))(v_cache[:, :, Sk - W:, :], rep, axis=1)
        scores = torch.einsum("bhqd,bhkd->bhqk", q, k) * (Dh ** -0.5)
        p = _softmax(scores, axis=-1)
        o = torch.einsum("bhqk,bhkd->bhqd", p, v)
        return (lambda x, *d: x.permute(*d))(o, 0, 2, 1, 3).reshape(B, Sq, Hq * Dh) @ wo

    def _B_ref(x, w_gate, w_up, w_down):
        g = _silu(x @ w_gate)
        u = x @ w_up
        return (g * u) @ w_down

    x = A_x
    xn = _layernorm(x, axis=-1)
    s = _A_ref(xn, A_k_cache, A_v_cache, A_wq, A_wo)
    g = _silu(_B_ref(xn, B_w_gate, B_w_up, B_w_down))
    return x + s * g
```

```asm
; @launch grid=(256,1,1) block=(640,1,1) lds=139264
.amdgcn_target "amdgcn-amd-amdhsa--gfx950"
.text
.globl recurrent_scan__sliding_block_cached__swiglu_ffn__decode_kernel
.p2align 8
.type recurrent_scan__sliding_block_cached__swiglu_ffn__decode_kernel,@function
recurrent_scan__sliding_block_cached__swiglu_ffn__decode_kernel:
s_cmp_ge_u32 s2, 256
s_cbranch_scc1 L_exit
s_load_dwordx16 s[8:23], s[0:1], 0
s_load_dwordx8 s[24:31], s[0:1], 64
v_lshrrev_b32 v1, 6, v0
v_and_b32 v0, 63, v0
v_readfirstlane_b32 s3, v1
s_and_b32 s40, s2, 7
s_lshr_b32 s41, s2, 3
s_and_b32 s42, s41, 7
s_and_b32 s41, s41, 0x18
s_add_u32 s41, s41, s40
s_mov_b32 s39, 0x10000
v_lshrrev_b32 v2, 4, v0
v_and_b32 v3, 15, v0
s_or_b32 s4, s3, s42
s_cmp_lg_u32 s4, 0
s_cbranch_scc1 L_nocpf
s_getpc_b64 s[6:7]
L_pcref:
s_sub_u32 s6, s6, L_pcref-recurrent_scan__sliding_block_cached__swiglu_ffn__decode_kernel
s_subb_u32 s7, s7, 0
v_lshlrev_b32 v4, 7, v0
v_min_u32 v4, L_exit-recurrent_scan__sliding_block_cached__swiglu_ffn__decode_kernel, v4
global_load_dword v160, v4, s[6:7]
v_lshlrev_b32 v5, 7, v0
v_add_u32 v5, 8192, v5
v_min_u32 v5, L_exit-recurrent_scan__sliding_block_cached__swiglu_ffn__decode_kernel, v5
global_load_dword v161, v5, s[6:7]
L_nocpf:
s_cmp_lt_u32 s3, 2
s_cbranch_scc1 L_helpers
s_sub_u32 s43, s3, 2
s_mul_i32 s4, s2, 5
s_mul_i32 s5, s43, 3
s_add_u32 s4, s4, s5
s_lshr_b32 s5, s2, 4
s_add_u32 s4, s4, s5
s_lshl_b32 s4, s4, 10
s_lshr_b32 s5, s42, 2
s_lshl_b32 s5, s5, 5
s_add_u32 s5, s5, s41
s_lshl_b32 s5, s5, 21
s_and_b32 s6, s42, 3
s_lshl_b32 s6, s6, 17
s_add_u32 s5, s5, s6
s_lshl_b32 s6, s43, 14
s_add_u32 s5, s5, s6
s_add_u32 s5, s5, 1572864
v_lshl_add_u32 v1, v0, 4, s5
v_bfe_u32 v12, v0, 3, 2
v_lshrrev_b32 v13, 5, v0
v_lshl_add_u32 v13, v12, 3, v13
v_lshlrev_b32 v13, 10, v13
v_lshrrev_b32 v12, 1, v12
v_lshlrev_b32 v12, 2, v12
v_and_b32 v14, 7, v0
v_xor_b32 v12, v12, v14
v_lshl_add_u32 v26, v12, 4, v13
s_lshl_b32 s5, s43, 7
s_lshl_b32 s40, s41, 17
s_add_u32 s5, s5, s40
v_add_u32 v26, s5, v26
s_mul_i32 s38, s43, 16896
s_add_u32 s38, s38, 4096
s_waitcnt lgkmcnt(0)
s_mov_b32 s44, s10
s_and_b32 s45, s11, 0xffff
s_mov_b32 s46, 0x8000000
s_mov_b32 s47, 0x20000
s_mov_b32 s60, s16
s_and_b32 s61, s17, 0xffff
s_mov_b32 s62, 0x400000
s_mov_b32 s63, 0x20000
s_add_u32 s6, s4, 0
s_and_b32 s6, s6, 0x3fff
buffer_load_dwordx4 v[32:35], v1, s[44:47], s6 offen nt
s_add_u32 m0, s38, 0
s_mov_b32 s7, 0x0
buffer_load_dwordx4 v26, s[60:63], s7 offen nt lds
s_add_u32 s6, s4, 1024
s_and_b32 s6, s6, 0x3fff
buffer_load_dwordx4 v[36:39], v1, s[44:47], s6 offen nt
s_add_u32 m0, s38, 1056
s_mov_b32 s7, 0x800
buffer_load_dwordx4 v26, s[60:63], s7 offen nt lds
s_add_u32 s6, s4, 2048
s_and_b32 s6, s6, 0x3fff
buffer_load_dwordx4 v[40:43], v1, s[44:47], s6 offen nt
s_add_u32 m0, s38, 2112
s_mov_b32 s7, 0x1000
buffer_load_dwordx4 v26, s[60:63], s7 offen nt lds
s_barrier
s_mov_b32 s48, s12
s_and_b32 s49, s13, 0xffff
s_mov_b32 s50, 0x8000000
s_mov_b32 s51, 0x20000
s_mov_b32 s64, s30
s_and_b32 s65, s31, 0xffff
s_mov_b32 s66, 0x130000
s_mov_b32 s67, 0x20000
v_and_b32 v12, 1, v3
v_lshlrev_b32 v12, 4, v12
v_mov_b32 v13, 0xffff
v_lshlrev_b32 v12, v12, v13
v_lshrrev_b32 v13, 1, v3
v_cmp_eq_u32 vcc, 0, v13
s_nop 1
v_cndmask_b32 v8, 0, v12, vcc
v_cmp_eq_u32 vcc, 1, v13
s_nop 1
v_cndmask_b32 v9, 0, v12, vcc
v_cmp_eq_u32 vcc, 2, v13
s_nop 1
v_cndmask_b32 v10, 0, v12, vcc
v_cmp_eq_u32 vcc, 3, v13
s_nop 1
v_cndmask_b32 v11, 0, v12, vcc
s_mov_b32 s72, 0x22222222
s_mov_b32 s73, 0x2222
s_mov_b32 s74, 0x6060606
s_mov_b32 s75, 0x606
s_mov_b32 s76, 0x0
s_mov_b32 s77, 0x0
s_mov_b32 s78, 0x0
s_mov_b32 s79, 0x0
s_lshl_b32 s80, s43, 3
s_lshr_b64 s[72:73], s[72:73], s80
s_lshr_b64 s[74:75], s[74:75], s80
s_lshr_b64 s[76:77], s[76:77], s80
s_lshr_b64 s[78:79], s[78:79], s80
s_bfm_b64 s[68:69], s72, s74
s_bfm_b64 s[70:71], s76, s78
s_bitcmp0_b64 s[68:69], 6
s_cbranch_scc1 L_pr0
s_waitcnt vmcnt(5)
L_pr0:
s_add_u32 s6, s4, 0
s_and_b32 s6, s6, 0x3fff
buffer_load_dwordx4 v[96:99], v1, s[48:51], s6 offen nt
v_lshl_add_u32 v18, v2, 3, v3
v_lshlrev_b32 v18, 2, v18
s_mul_i32 s40, s43, 272
v_add_u32 v18, s40, v18
s_lshl_b32 s40, s43, 3
v_mov_b32 v20, s40
v_and_b32 v19, 7, v0
v_mul_u32_u24 v19, 272, v19
v_lshl_add_u32 v19, v2, 4, v19
v_lshrrev_b32 v12, 3, v3
v_lshl_add_u32 v19, v12, 7, v19
v_and_b32 v21, 1, v2
v_lshlrev_b32 v21, 4, v21
v_mul_u32_u24 v27, 1056, v2
v_lshrrev_b32 v12, 2, v3
v_lshl_add_u32 v27, v12, 7, v27
v_and_b32 v13, 3, v3
v_lshl_add_u32 v27, v13, 4, v27
v_add_u32 v27, s38, v27
v_lshrrev_b32 v12, 3, v3
v_lshlrev_b32 v12, 6, v12
v_sub_u32 v15, v27, v12
v_add_u32 v27, v27, v12
s_waitcnt vmcnt(6)
s_bitcmp0_b64 s[68:69], 7
s_cbranch_scc1 L_pr1
s_waitcnt vmcnt(5)
L_pr1:
s_add_u32 s7, s4, 3072
s_and_b32 s7, s7, 0x3fff
buffer_load_dwordx4 v[44:47], v1, s[44:47], s7 offen nt
v_lshlrev_b32 v25, 4, v3
s_and_b32 s5, s42, 3
s_lshl_b32 s5, s5, 1
s_lshr_b32 s40, s42, 2
s_add_u32 s5, s5, s40
s_lshl_b32 s5, s5, 12
s_lshl_b32 s40, s43, 9
s_add_u32 s5, s5, s40
s_add_u32 s5, s5, 0x10000
v_lshrrev_b32 v12, 1, v2
v_and_b32 v13, 1, v3
v_lshlrev_b32 v16, 2, v13
v_lshl_add_u32 v16, v12, 7, v16
v_and_b32 v12, 1, v2
v_lshl_add_u32 v16, v12, 8, v16
v_lshrrev_b32 v12, 1, v3
v_lshl_add_u32 v16, v12, 3, v16
v_xor_b32 v17, 4, v16
s_mov_b32 s34, 0xaaaaaaaa
s_mov_b32 s35, 0xaaaaaaaa
s_waitcnt vmcnt(6)
s_bitcmp0_b64 s[68:69], 8
s_cbranch_scc1 L_pr2
s_waitcnt vmcnt(5)
L_pr2:
s_add_u32 m0, s38, 3168
s_mov_b32 s6, 0x1800
buffer_load_dwordx4 v26, s[60:63], s6 offen nt lds
s_waitcnt vmcnt(6)
s_bitcmp0_b64 s[68:69], 9
s_cbranch_scc1 L_pr3
s_waitcnt vmcnt(5)
L_pr3:
s_add_u32 s7, s4, 4096
s_and_b32 s7, s7, 0x3fff
buffer_load_dwordx4 v[48:51], v1, s[44:47], s7 offen nt
s_waitcnt vmcnt(6)
s_bitcmp0_b64 s[68:69], 10
s_cbranch_scc1 L_pr4
s_waitcnt vmcnt(5)
L_pr4:
s_add_u32 m0, s38, 4224
s_mov_b32 s6, 0x8000
buffer_load_dwordx4 v26, s[60:63], s6 offen nt lds
s_waitcnt vmcnt(6)
s_bitcmp0_b64 s[68:69], 11
s_cbranch_scc1 L_pr5
s_waitcnt vmcnt(5)
L_pr5:
s_add_u32 s7, s4, 5120
s_and_b32 s7, s7, 0x3fff
buffer_load_dwordx4 v[52:55], v1, s[44:47], s7 offen nt
s_waitcnt vmcnt(6)
s_bitcmp0_b64 s[68:69], 12
s_cbranch_scc1 L_pr6
s_waitcnt vmcnt(5)
L_pr6:
s_add_u32 m0, s38, 5280
s_mov_b32 s6, 0x8800
buffer_load_dwordx4 v26, s[60:63], s6 offen nt lds
s_waitcnt vmcnt(6)
s_bitcmp0_b64 s[68:69], 13
s_cbranch_scc1 L_pr7
s_waitcnt vmcnt(5)
L_pr7:
s_add_u32 s7, s4, 6144
s_and_b32 s7, s7, 0x3fff
buffer_load_dwordx4 v[56:59], v1, s[44:47], s7 offen nt
s_waitcnt vmcnt(6)
s_bitcmp0_b64 s[68:69], 14
s_cbranch_scc1 L_pr8
s_waitcnt vmcnt(5)
L_pr8:
s_add_u32 m0, s38, 6336
s_mov_b32 s6, 0x9000
buffer_load_dwordx4 v26, s[60:63], s6 offen nt lds
s_waitcnt vmcnt(6)
s_bitcmp0_b64 s[68:69], 15
s_cbranch_scc1 L_pr9
s_waitcnt vmcnt(5)
L_pr9:
s_add_u32 s7, s4, 7168
s_and_b32 s7, s7, 0x3fff
buffer_load_dwordx4 v[60:63], v1, s[44:47], s7 offen nt
s_waitcnt vmcnt(6)
s_bitcmp0_b64 s[68:69], 16
s_cbranch_scc1 L_pr10
s_waitcnt vmcnt(5)
L_pr10:
s_add_u32 m0, s38, 7392
s_mov_b32 s6, 0x9800
buffer_load_dwordx4 v26, s[60:63], s6 offen nt lds
s_waitcnt vmcnt(6)
s_bitcmp0_b64 s[68:69], 17
s_cbranch_scc1 L_pr11
s_waitcnt vmcnt(5)
L_pr11:
s_add_u32 s7, s4, 8192
s_and_b32 s7, s7, 0x3fff
buffer_load_dwordx4 v[64:67], v1, s[44:47], s7 offen nt
s_waitcnt vmcnt(6)
s_bitcmp0_b64 s[68:69], 18
s_cbranch_scc1 L_pr12
s_waitcnt vmcnt(5)
L_pr12:
s_add_u32 m0, s38, 8448
s_mov_b32 s6, 0x10000
buffer_load_dwordx4 v26, s[60:63], s6 offen nt lds
s_waitcnt vmcnt(6)
s_bitcmp0_b64 s[68:69], 19
s_cbranch_scc1 L_pr13
s_waitcnt vmcnt(5)
L_pr13:
s_add_u32 s7, s4, 9216
s_and_b32 s7, s7, 0x3fff
buffer_load_dwordx4 v[68:71], v1, s[44:47], s7 offen nt
s_waitcnt vmcnt(6)
s_bitcmp0_b64 s[68:69], 20
s_cbranch_scc1 L_pr14
s_waitcnt vmcnt(5)
L_pr14:
s_add_u32 m0, s38, 9504
s_mov_b32 s6, 0x10800
buffer_load_dwordx4 v26, s[60:63], s6 offen nt lds
s_waitcnt vmcnt(6)
s_bitcmp0_b64 s[68:69], 21
s_cbranch_scc1 L_pr15
s_waitcnt vmcnt(5)
L_pr15:
s_add_u32 s7, s4, 10240
s_and_b32 s7, s7, 0x3fff
buffer_load_dwordx4 v[72:75], v1, s[44:47], s7 offen nt
s_mov_b64 exec, 1
ds_write_b32 v20, v1 offset:2432
s_mov_b64 exec, -1
s_waitcnt vmcnt(6)
s_bitcmp0_b64 s[68:69], 22
s_cbranch_scc1 L_pr16
s_waitcnt vmcnt(5)
L_pr16:
s_add_u32 m0, s38, 10560
s_mov_b32 s6, 0x11000
buffer_load_dwordx4 v26, s[60:63], s6 offen nt lds
s_waitcnt vmcnt(6)
s_bitcmp0_b64 s[68:69], 23
s_cbranch_scc1 L_pr17
s_waitcnt vmcnt(5)
L_pr17:
s_add_u32 s7, s4, 11264
s_and_b32 s7, s7, 0x3fff
buffer_load_dwordx4 v[76:79], v1, s[44:47], s7 offen nt
s_waitcnt vmcnt(6)
s_bitcmp0_b64 s[68:69], 24
s_cbranch_scc1 L_pr18
s_waitcnt vmcnt(5)
L_pr18:
s_add_u32 m0, s38, 11616
s_mov_b32 s6, 0x11800
buffer_load_dwordx4 v26, s[60:63], s6 offen nt lds
s_waitcnt vmcnt(6)
s_bitcmp0_b64 s[68:69], 25
s_cbranch_scc1 L_pr19
s_waitcnt vmcnt(5)
L_pr19:
s_add_u32 s7, s4, 12288
s_and_b32 s7, s7, 0x3fff
buffer_load_dwordx4 v[80:83], v1, s[44:47], s7 offen nt
s_waitcnt vmcnt(6)
s_bitcmp0_b64 s[68:69], 26
s_cbranch_scc1 L_pr20
s_waitcnt vmcnt(5)
L_pr20:
s_add_u32 m0, s38, 12672
s_mov_b32 s6, 0x18000
buffer_load_dwordx4 v26, s[60:63], s6 offen nt lds
s_waitcnt vmcnt(6)
s_bitcmp0_b64 s[68:69], 27
s_cbranch_scc1 L_pr21
s_waitcnt vmcnt(5)
L_pr21:
s_add_u32 s7, s4, 13312
s_and_b32 s7, s7, 0x3fff
buffer_load_dwordx4 v[84:87], v1, s[44:47], s7 offen nt
s_waitcnt vmcnt(6)
s_bitcmp0_b64 s[68:69], 28
s_cbranch_scc1 L_pr22
s_waitcnt vmcnt(5)
L_pr22:
s_add_u32 m0, s38, 13728
s_mov_b32 s6, 0x18800
buffer_load_dwordx4 v26, s[60:63], s6 offen nt lds
s_waitcnt vmcnt(6)
s_bitcmp0_b64 s[68:69], 29
s_cbranch_scc1 L_pr23
s_waitcnt vmcnt(5)
L_pr23:
s_add_u32 s7, s4, 14336
s_and_b32 s7, s7, 0x3fff
buffer_load_dwordx4 v[88:91], v1, s[44:47], s7 offen nt
s_waitcnt vmcnt(6)
s_bitcmp0_b64 s[68:69], 30
s_cbranch_scc1 L_pr24
s_waitcnt vmcnt(5)
L_pr24:
s_add_u32 m0, s38, 14784
s_mov_b32 s6, 0x19000
buffer_load_dwordx4 v26, s[60:63], s6 offen nt lds
s_waitcnt vmcnt(6)
s_bitcmp0_b64 s[68:69], 31
s_cbranch_scc1 L_pr25
s_waitcnt vmcnt(5)
L_pr25:
s_add_u32 s7, s4, 15360
s_and_b32 s7, s7, 0x3fff
buffer_load_dwordx4 v[92:95], v1, s[44:47], s7 offen nt
s_waitcnt vmcnt(6)
s_bitcmp0_b64 s[68:69], 32
s_cbranch_scc1 L_pr26
s_waitcnt vmcnt(5)
L_pr26:
s_add_u32 m0, s38, 15840
s_mov_b32 s6, 0x19800
buffer_load_dwordx4 v26, s[60:63], s6 offen nt lds
s_waitcnt vmcnt(6)
s_bitcmp0_b64 s[68:69], 33
s_cbranch_scc1 L_pr27
s_waitcnt vmcnt(5)
L_pr27:
s_add_u32 s7, s4, 1024
s_and_b32 s7, s7, 0x3fff
buffer_load_dwordx4 v[100:103], v1, s[48:51], s7 offen nt
s_waitcnt vmcnt(6)
s_bitcmp0_b64 s[68:69], 34
s_cbranch_scc1 L_pr28
s_waitcnt vmcnt(5)
L_pr28:
s_add_u32 s6, s4, 2048
s_and_b32 s6, s6, 0x3fff
buffer_load_dwordx4 v[104:107], v1, s[48:51], s6 offen nt
s_waitcnt vmcnt(6)
s_bitcmp0_b64 s[68:69], 35
s_cbranch_scc1 L_pr29
s_waitcnt vmcnt(5)
L_pr29:
s_add_u32 s7, s4, 3072
s_and_b32 s7, s7, 0x3fff
buffer_load_dwordx4 v[108:111], v1, s[48:51], s7 offen nt
s_waitcnt vmcnt(6)
s_bitcmp0_b64 s[68:69], 36
s_cbranch_scc1 L_pr30
s_waitcnt vmcnt(5)
L_pr30:
s_add_u32 s6, s4, 4096
s_and_b32 s6, s6, 0x3fff
buffer_load_dwordx4 v[112:115], v1, s[48:51], s6 offen nt
s_waitcnt vmcnt(6)
s_bitcmp0_b64 s[68:69], 37
s_cbranch_scc1 L_pr31
s_waitcnt vmcnt(5)
L_pr31:
s_add_u32 s7, s4, 5120
s_and_b32 s7, s7, 0x3fff
buffer_load_dwordx4 v[116:119], v1, s[48:51], s7 offen nt
L_kv_q32:
ds_read_b32 v12, v21 offset:2496
ds_read_b128 v[4:7], v25 offset:3840
s_waitcnt lgkmcnt(0)
v_cmp_eq_u32 vcc, 0, v12
s_cbranch_vccz L_kv_q32_ok
s_sub_u32 s39, s39, 1
s_cbranch_scc1 L_timeout
s_branch L_kv_q32
L_kv_q32_ok:
s_waitcnt vmcnt(6)
s_bitcmp0_b64 s[68:69], 38
s_cbranch_scc1 L_pr33
s_waitcnt vmcnt(5)
L_pr33:
s_add_u32 s6, s4, 6144
s_and_b32 s6, s6, 0x3fff
buffer_load_dwordx4 v[120:123], v1, s[48:51], s6 offen nt
s_waitcnt lgkmcnt(0)
v_dot2_f32_bf16 v160, v32, v4, 0
v_dot2_f32_bf16 v161, v36, v4, 0
v_dot2_f32_bf16 v162, v40, v4, 0
v_dot2_f32_bf16 v163, v44, v4, 0
v_dot2_f32_bf16 v160, v33, v5, v160
v_dot2_f32_bf16 v161, v37, v5, v161
v_dot2_f32_bf16 v162, v41, v5, v162
v_dot2_f32_bf16 v163, v45, v5, v163
v_dot2_f32_bf16 v160, v34, v6, v160
v_dot2_f32_bf16 v161, v38, v6, v161
v_dot2_f32_bf16 v162, v42, v6, v162
v_dot2_f32_bf16 v163, v46, v6, v163
v_dot2_f32_bf16 v160, v35, v7, v160
v_dot2_f32_bf16 v161, v39, v7, v161
v_dot2_f32_bf16 v162, v43, v7, v162
v_dot2_f32_bf16 v163, v47, v7, v163
v_add_f32_dpp v22, v160, v160 row_ror:8 row_mask:0xf bank_mask:0x3
v_add_f32_dpp v164, v161, v161 row_ror:8 row_mask:0xf bank_mask:0x3
s_nop 0
v_add_f32_dpp v22, v162, v162 row_ror:8 row_mask:0xf bank_mask:0xc
v_add_f32_dpp v164, v163, v163 row_ror:8 row_mask:0xf bank_mask:0xc
s_nop 0
v_add_f32_dpp v22, v22, v22 row_half_mirror row_mask:0xf bank_mask:0x5
s_nop 1
v_add_f32_dpp v22, v164, v164 row_half_mirror row_mask:0xf bank_mask:0xa
s_nop 1
v_add_f32_dpp v22, v22, v22 quad_perm:[1,0,3,2] row_mask:0xf bank_mask:0xf
s_nop 1
v_add_f32_dpp v22, v22, v22 quad_perm:[2,3,0,1] row_mask:0xf bank_mask:0xf
v_dot2_f32_bf16 v160, v48, v4, 0
v_dot2_f32_bf16 v161, v52, v4, 0
v_dot2_f32_bf16 v162, v56, v4, 0
v_dot2_f32_bf16 v163, v60, v4, 0
v_dot2_f32_bf16 v160, v49, v5, v160
v_dot2_f32_bf16 v161, v53, v5, v161
v_dot2_f32_bf16 v162, v57, v5, v162
v_dot2_f32_bf16 v163, v61, v5, v163
v_dot2_f32_bf16 v160, v50, v6, v160
v_dot2_f32_bf16 v161, v54, v6, v161
v_dot2_f32_bf16 v162, v58, v6, v162
v_dot2_f32_bf16 v163, v62, v6, v163
v_dot2_f32_bf16 v160, v51, v7, v160
v_dot2_f32_bf16 v161, v55, v7, v161
v_dot2_f32_bf16 v162, v59, v7, v162
v_dot2_f32_bf16 v163, v63, v7, v163
v_add_f32_dpp v23, v160, v160 row_ror:8 row_mask:0xf bank_mask:0x3
v_add_f32_dpp v164, v161, v161 row_ror:8 row_mask:0xf bank_mask:0x3
s_nop 0
v_add_f32_dpp v23, v162, v162 row_ror:8 row_mask:0xf bank_mask:0xc
v_add_f32_dpp v164, v163, v163 row_ror:8 row_mask:0xf bank_mask:0xc
s_nop 0
v_add_f32_dpp v23, v23, v23 row_half_mirror row_mask:0xf bank_mask:0x5
s_nop 1
v_add_f32_dpp v23, v164, v164 row_half_mirror row_mask:0xf bank_mask:0xa
s_nop 1
v_add_f32_dpp v23, v23, v23 quad_perm:[1,0,3,2] row_mask:0xf bank_mask:0xf
s_nop 1
v_add_f32_dpp v23, v23, v23 quad_perm:[2,3,0,1] row_mask:0xf bank_mask:0xf
ds_read_b64_tr_b16 v[32:33], v27 offset:0
ds_read_b64_tr_b16 v[34:35], v27 offset:512
s_waitcnt vmcnt(6)
s_bitcmp0_b64 s[68:69], 39
s_cbranch_scc1 L_pr34
s_waitcnt vmcnt(5)
L_pr34:
s_add_u32 s7, s4, 7168
s_and_b32 s7, s7, 0x3fff
buffer_load_dwordx4 v[124:127], v1, s[48:51], s7 offen nt
v_dot2_f32_bf16 v160, v64, v4, 0
v_dot2_f32_bf16 v161, v68, v4, 0
v_dot2_f32_bf16 v162, v72, v4, 0
v_dot2_f32_bf16 v163, v76, v4, 0
v_dot2_f32_bf16 v160, v65, v5, v160
v_dot2_f32_bf16 v161, v69, v5, v161
v_dot2_f32_bf16 v162, v73, v5, v162
v_dot2_f32_bf16 v163, v77, v5, v163
v_dot2_f32_bf16 v160, v66, v6, v160
v_dot2_f32_bf16 v161, v70, v6, v161
v_dot2_f32_bf16 v162, v74, v6, v162
v_dot2_f32_bf16 v163, v78, v6, v163
v_dot2_f32_bf16 v160, v67, v7, v160
v_dot2_f32_bf16 v161, v71, v7, v161
v_dot2_f32_bf16 v162, v75, v7, v162
v_dot2_f32_bf16 v163, v79, v7, v163
v_add_f32_dpp v24, v160, v160 row_ror:8 row_mask:0xf bank_mask:0x3
v_add_f32_dpp v164, v161, v161 row_ror:8 row_mask:0xf bank_mask:0x3
s_nop 0
v_add_f32_dpp v24, v162, v162 row_ror:8 row_mask:0xf bank_mask:0xc
v_add_f32_dpp v164, v163, v163 row_ror:8 row_mask:0xf bank_mask:0xc
s_nop 0
v_add_f32_dpp v24, v24, v24 row_half_mirror row_mask:0xf bank_mask:0x5
s_nop 1
v_add_f32_dpp v24, v164, v164 row_half_mirror row_mask:0xf bank_mask:0xa
s_nop 1
v_add_f32_dpp v24, v24, v24 quad_perm:[1,0,3,2] row_mask:0xf bank_mask:0xf
s_nop 1
v_add_f32_dpp v24, v24, v24 quad_perm:[2,3,0,1] row_mask:0xf bank_mask:0xf
v_dot2_f32_bf16 v160, v80, v4, 0
v_dot2_f32_bf16 v161, v84, v4, 0
v_dot2_f32_bf16 v162, v88, v4, 0
v_dot2_f32_bf16 v163, v92, v4, 0
v_dot2_f32_bf16 v160, v81, v5, v160
v_dot2_f32_bf16 v161, v85, v5, v161
v_dot2_f32_bf16 v162, v89, v5, v162
v_dot2_f32_bf16 v163, v93, v5, v163
v_dot2_f32_bf16 v160, v82, v6, v160
v_dot2_f32_bf16 v161, v86, v6, v161
v_dot2_f32_bf16 v162, v90, v6, v162
v_dot2_f32_bf16 v163, v94, v6, v163
v_dot2_f32_bf16 v160, v83, v7, v160
v_dot2_f32_bf16 v161, v87, v7, v161
v_dot2_f32_bf16 v162, v91, v7, v162
v_dot2_f32_bf16 v163, v95, v7, v163
v_add_f32_dpp v25, v160, v160 row_ror:8 row_mask:0xf bank_mask:0x3
v_add_f32_dpp v164, v161, v161 row_ror:8 row_mask:0xf bank_mask:0x3
s_nop 0
v_add_f32_dpp v25, v162, v162 row_ror:8 row_mask:0xf bank_mask:0xc
v_add_f32_dpp v164, v163, v163 row_ror:8 row_mask:0xf bank_mask:0xc
s_nop 0
v_add_f32_dpp v25, v25, v25 row_half_mirror row_mask:0xf bank_mask:0x5
s_nop 1
v_add_f32_dpp v25, v164, v164 row_half_mirror row_mask:0xf bank_mask:0xa
s_nop 1
v_add_f32_dpp v25, v25, v25 quad_perm:[1,0,3,2] row_mask:0xf bank_mask:0xf
s_nop 1
v_add_f32_dpp v25, v25, v25 quad_perm:[2,3,0,1] row_mask:0xf bank_mask:0xf
ds_read_b64_tr_b16 v[40:41], v27 offset:8
ds_read_b64_tr_b16 v[42:43], v27 offset:520
s_waitcnt vmcnt(6)
s_add_u32 s6, s4, 8192
s_and_b32 s6, s6, 0x3fff
buffer_load_dwordx4 v[128:131], v1, s[48:51], s6 offen nt
v_cvt_pk_bf16_f32 v12, v22, v23
v_cvt_pk_bf16_f32 v13, v24, v25
ds_read_b64_tr_b16 v[48:49], v15 offset:64
v_lshlrev_b32 v22, 16, v12
v_and_b32 v23, 0xffff0000, v12
v_lshlrev_b32 v24, 16, v13
v_and_b32 v25, 0xffff0000, v13
v_mul_f32 v22, 0x3db504f3, v22
v_mul_f32 v23, 0x3db504f3, v23
v_mul_f32 v24, 0x3db504f3, v24
v_mul_f32 v25, 0x3db504f3, v25
v_cvt_pk_bf16_f32 v12, v22, v23
v_cvt_pk_bf16_f32 v13, v24, v25
ds_read_b64_tr_b16 v[50:51], v15 offset:576
v_lshlrev_b32 v22, 16, v12
v_and_b32 v23, 0xffff0000, v12
v_lshlrev_b32 v24, 16, v13
v_and_b32 v25, 0xffff0000, v13
v_max3_f32 v12, v22, v23, v24
v_max_f32 v12, v12, v25
ds_read_b64_tr_b16 v[56:57], v15 offset:72
ds_read_b64_tr_b16 v[58:59], v15 offset:584
v_max_f32_dpp v12, v12, v12 row_ror:4 row_mask:0xf bank_mask:0xf
ds_read_b64_tr_b16 v[36:37], v27 offset:4224
ds_read_b64_tr_b16 v[38:39], v27 offset:4736
v_max_f32_dpp v12, v12, v12 row_ror:8 row_mask:0xf bank_mask:0xf
ds_read_b64_tr_b16 v[44:45], v27 offset:4232
ds_read_b64_tr_b16 v[46:47], v27 offset:4744
v_max_f32_dpp v12, v12, v12 row_bcast:15 row_mask:0xa bank_mask:0xf
ds_read_b64_tr_b16 v[52:53], v15 offset:4288
ds_read_b64_tr_b16 v[54:55], v15 offset:4800
v_max_f32_dpp v12, v12, v12 row_bcast:31 row_mask:0xc bank_mask:0xf
ds_read_b64_tr_b16 v[60:61], v15 offset:4296
v_readlane_b32 s40, v12, 63
ds_read_b64_tr_b16 v[62:63], v15 offset:4808
ds_read_b64_tr_b16 v[64:65], v27 offset:8448
s_waitcnt vmcnt(6)
s_add_u32 s7, s4, 9216
s_and_b32 s7, s7, 0x3fff
buffer_load_dwordx4 v[132:135], v1, s[48:51], s7 offen nt
v_subrev_f32 v22, s40, v22
v_subrev_f32 v23, s40, v23
v_subrev_f32 v24, s40, v24
v_subrev_f32 v25, s40, v25
v_mul_f32 v22, 0x3fb8aa3b, v22
v_mul_f32 v23, 0x3fb8aa3b, v23
v_mul_f32 v24, 0x3fb8aa3b, v24
v_mul_f32 v25, 0x3fb8aa3b, v25
v_exp_f32 v22, v22
v_exp_f32 v23, v23
v_exp_f32 v24, v24
v_exp_f32 v25, v25
v_mov_b32 v12, s40
v_add_f32 v13, v22, v23
v_add_f32 v14, v24, v25
v_cvt_pk_bf16_f32 v22, v22, v22
v_cvt_pk_bf16_f32 v23, v23, v23
v_cvt_pk_bf16_f32 v24, v24, v24
v_cvt_pk_bf16_f32 v25, v25, v25
v_add_f32 v13, v13, v14
ds_read_b64_tr_b16 v[66:67], v27 offset:8960
ds_read_b64_tr_b16 v[72:73], v27 offset:8456
v_add_f32_dpp v13, v13, v13 row_ror:4 row_mask:0xf bank_mask:0xf
ds_read_b64_tr_b16 v[74:75], v27 offset:8968
ds_read_b64_tr_b16 v[80:81], v15 offset:8512
v_add_f32_dpp v13, v13, v13 row_ror:8 row_mask:0xf bank_mask:0xf
ds_read_b64_tr_b16 v[82:83], v15 offset:9024
ds_read_b64_tr_b16 v[88:89], v15 offset:8520
v_add_f32_dpp v13, v13, v13 row_bcast:15 row_mask:0xa bank_mask:0xf
ds_read_b64_tr_b16 v[90:91], v15 offset:9032
ds_read_b64_tr_b16 v[68:69], v27 offset:12672
v_add_f32_dpp v13, v13, v13 row_bcast:31 row_mask:0xc bank_mask:0xf
s_mov_b32 exec_lo, 0
s_mov_b32 exec_hi, 0x80000000
ds_write_b64 v20, v[12:13] offset:2176
s_mov_b64 exec, -1
v_lshlrev_b32 v14, 4, v3
v_lshl_add_u32 v14, v2, 3, v14
ds_read_b64_tr_b16 v[70:71], v27 offset:13184
ds_read_b64_tr_b16 v[76:77], v27 offset:12680
s_waitcnt vmcnt(6)
s_add_u32 s6, s4, 10240
s_and_b32 s6, s6, 0x3fff
buffer_load_dwordx4 v[136:139], v1, s[48:51], s6 offen nt
v_and_b32_dpp v160, v22, v8 row_newbcast:0 row_mask:0xf bank_mask:0xf
v_and_b32_dpp v161, v22, v9 row_newbcast:0 row_mask:0xf bank_mask:0xf
v_and_b32_dpp v162, v22, v10 row_newbcast:0 row_mask:0xf bank_mask:0xf
v_and_b32_dpp v163, v22, v11 row_newbcast:0 row_mask:0xf bank_mask:0xf
ds_read_b64_tr_b16 v[78:79], v27 offset:13192
ds_read_b64_tr_b16 v[84:85], v15 offset:12736
v_mfma_f32_16x16x32_bf16 v[28:31], v[96:99], v[160:163], 0
v_and_b32_dpp v164, v22, v8 row_newbcast:4 row_mask:0xf bank_mask:0xf
v_and_b32_dpp v165, v22, v9 row_newbcast:4 row_mask:0xf bank_mask:0xf
v_and_b32_dpp v166, v22, v10 row_newbcast:4 row_mask:0xf bank_mask:0xf
v_and_b32_dpp v167, v22, v11 row_newbcast:4 row_mask:0xf bank_mask:0xf
ds_read_b64_tr_b16 v[86:87], v15 offset:13248
ds_read_b64_tr_b16 v[92:93], v15 offset:12744
v_mfma_f32_16x16x32_bf16 v[28:31], v[100:103], v[164:167], v[28:31]
v_and_b32_dpp v160, v22, v8 row_newbcast:8 row_mask:0xf bank_mask:0xf
v_and_b32_dpp v161, v22, v9 row_newbcast:8 row_mask:0xf bank_mask:0xf
v_and_b32_dpp v162, v22, v10 row_newbcast:8 row_mask:0xf bank_mask:0xf
v_and_b32_dpp v163, v22, v11 row_newbcast:8 row_mask:0xf bank_mask:0xf
ds_read_b64_tr_b16 v[94:95], v15 offset:13256
s_nop 0
v_mfma_f32_16x16x32_bf16 v[28:31], v[104:107], v[160:163], v[28:31]
v_and_b32_dpp v164, v22, v8 row_newbcast:12 row_mask:0xf bank_mask:0xf
v_and_b32_dpp v165, v22, v9 row_newbcast:12 row_mask:0xf bank_mask:0xf
v_and_b32_dpp v166, v22, v10 row_newbcast:12 row_mask:0xf bank_mask:0xf
v_and_b32_dpp v167, v22, v11 row_newbcast:12 row_mask:0xf bank_mask:0xf
s_nop 1
v_mfma_f32_16x16x32_bf16 v[28:31], v[108:111], v[164:167], v[28:31]
s_waitcnt vmcnt(6)
s_add_u32 s7, s4, 11264
s_and_b32 s7, s7, 0x3fff
buffer_load_dwordx4 v[140:143], v1, s[48:51], s7 offen nt
v_and_b32_dpp v160, v23, v8 row_newbcast:0 row_mask:0xf bank_mask:0xf
v_and_b32_dpp v161, v23, v9 row_newbcast:0 row_mask:0xf bank_mask:0xf
v_and_b32_dpp v162, v23, v10 row_newbcast:0 row_mask:0xf bank_mask:0xf
v_and_b32_dpp v163, v23, v11 row_newbcast:0 row_mask:0xf bank_mask:0xf
s_nop 1
v_mfma_f32_16x16x32_bf16 v[28:31], v[112:115], v[160:163], v[28:31]
s_waitcnt vmcnt(6)
s_add_u32 s6, s4, 12288
s_and_b32 s6, s6, 0x3fff
buffer_load_dwordx4 v[144:147], v1, s[48:51], s6 offen nt
v_and_b32_dpp v164, v23, v8 row_newbcast:4 row_mask:0xf bank_mask:0xf
v_and_b32_dpp v165, v23, v9 row_newbcast:4 row_mask:0xf bank_mask:0xf
v_and_b32_dpp v166, v23, v10 row_newbcast:4 row_mask:0xf bank_mask:0xf
v_and_b32_dpp v167, v23, v11 row_newbcast:4 row_mask:0xf bank_mask:0xf
s_nop 1
v_mfma_f32_16x16x32_bf16 v[28:31], v[116:119], v[164:167], v[28:31]
s_waitcnt vmcnt(6)
s_add_u32 s7, s4, 13312
s_and_b32 s7, s7, 0x3fff
buffer_load_dwordx4 v[148:151], v1, s[48:51], s7 offen nt
v_and_b32_dpp v160, v23, v8 row_newbcast:8 row_mask:0xf bank_mask:0xf
v_and_b32_dpp v161, v23, v9 row_newbcast:8 row_mask:0xf bank_mask:0xf
v_and_b32_dpp v162, v23, v10 row_newbcast:8 row_mask:0xf bank_mask:0xf
v_and_b32_dpp v163, v23, v11 row_newbcast:8 row_mask:0xf bank_mask:0xf
s_nop 1
v_mfma_f32_16x16x32_bf16 v[28:31], v[120:123], v[160:163], v[28:31]
s_waitcnt vmcnt(6)
s_add_u32 s6, s4, 14336
s_and_b32 s6, s6, 0x3fff
buffer_load_dwordx4 v[152:155], v1, s[48:51], s6 offen nt
v_and_b32_dpp v164, v23, v8 row_newbcast:12 row_mask:0xf bank_mask:0xf
v_and_b32_dpp v165, v23, v9 row_newbcast:12 row_mask:0xf bank_mask:0xf
v_and_b32_dpp v166, v23, v10 row_newbcast:12 row_mask:0xf bank_mask:0xf
v_and_b32_dpp v167, v23, v11 row_newbcast:12 row_mask:0xf bank_mask:0xf
s_nop 1
v_mfma_f32_16x16x32_bf16 v[28:31], v[124:127], v[164:167], v[28:31]
s_waitcnt vmcnt(6)
s_add_u32 s7, s4, 15360
s_and_b32 s7, s7, 0x3fff
buffer_load_dwordx4 v[156:159], v1, s[48:51], s7 offen nt
s_mov_b32 s40, 0xffffff00
v_and_b32_dpp v160, v24, v8 row_newbcast:0 row_mask:0xf bank_mask:0xf
v_and_b32_dpp v161, v24, v9 row_newbcast:0 row_mask:0xf bank_mask:0xf
v_and_b32_dpp v162, v24, v10 row_newbcast:0 row_mask:0xf bank_mask:0xf
v_and_b32_dpp v163, v24, v11 row_newbcast:0 row_mask:0xf bank_mask:0xf
s_nop 1
v_mfma_f32_16x16x32_bf16 v[28:31], v[128:131], v[160:163], v[28:31]
v_and_b32_dpp v164, v24, v8 row_newbcast:4 row_mask:0xf bank_mask:0xf
v_and_b32_dpp v165, v24, v9 row_newbcast:4 row_mask:0xf bank_mask:0xf
v_and_b32_dpp v166, v24, v10 row_newbcast:4 row_mask:0xf bank_mask:0xf
v_and_b32_dpp v167, v24, v11 row_newbcast:4 row_mask:0xf bank_mask:0xf
s_waitcnt vmcnt(6)
s_nop 0
v_mfma_f32_16x16x32_bf16 v[28:31], v[132:135], v[164:167], v[28:31]
v_and_b32_dpp v160, v24, v8 row_newbcast:8 row_mask:0xf bank_mask:0xf
v_and_b32_dpp v161, v24, v9 row_newbcast:8 row_mask:0xf bank_mask:0xf
v_and_b32_dpp v162, v24, v10 row_newbcast:8 row_mask:0xf bank_mask:0xf
v_and_b32_dpp v163, v24, v11 row_newbcast:8 row_mask:0xf bank_mask:0xf
v_lshrrev_b32 v104, 3, v3
v_mul_u32_u24 v104, 0xaaaa, v104
v_add_u32 v104, 0x4444, v104
s_waitcnt vmcnt(5)
v_mfma_f32_16x16x32_bf16 v[28:31], v[136:139], v[160:163], v[28:31]
v_and_b32_dpp v164, v24, v8 row_newbcast:12 row_mask:0xf bank_mask:0xf
v_and_b32_dpp v165, v24, v9 row_newbcast:12 row_mask:0xf bank_mask:0xf
v_and_b32_dpp v166, v24, v10 row_newbcast:12 row_mask:0xf bank_mask:0xf
v_and_b32_dpp v167, v24, v11 row_newbcast:12 row_mask:0xf bank_mask:0xf
v_mov_b64 v[116:117], 0
v_mov_b64 v[118:119], 0
s_waitcnt vmcnt(4)
v_mfma_f32_16x16x32_bf16 v[28:31], v[140:143], v[164:167], v[28:31]
v_and_b32_dpp v160, v25, v8 row_newbcast:0 row_mask:0xf bank_mask:0xf
v_and_b32_dpp v161, v25, v9 row_newbcast:0 row_mask:0xf bank_mask:0xf
v_and_b32_dpp v162, v25, v10 row_newbcast:0 row_mask:0xf bank_mask:0xf
v_and_b32_dpp v163, v25, v11 row_newbcast:0 row_mask:0xf bank_mask:0xf
v_mov_b64 v[120:121], 0
v_mov_b64 v[122:123], 0
s_waitcnt vmcnt(3)
v_mfma_f32_16x16x32_bf16 v[28:31], v[144:147], v[160:163], v[28:31]
v_and_b32_dpp v164, v25, v8 row_newbcast:4 row_mask:0xf bank_mask:0xf
v_and_b32_dpp v165, v25, v9 row_newbcast:4 row_mask:0xf bank_mask:0xf
v_and_b32_dpp v166, v25, v10 row_newbcast:4 row_mask:0xf bank_mask:0xf
v_and_b32_dpp v167, v25, v11 row_newbcast:4 row_mask:0xf bank_mask:0xf
v_mov_b64 v[124:125], 0
v_mov_b64 v[126:127], 0
s_waitcnt vmcnt(2)
v_mfma_f32_16x16x32_bf16 v[28:31], v[148:151], v[164:167], v[28:31]
v_and_b32_dpp v160, v25, v8 row_newbcast:8 row_mask:0xf bank_mask:0xf
v_and_b32_dpp v161, v25, v9 row_newbcast:8 row_mask:0xf bank_mask:0xf
v_and_b32_dpp v162, v25, v10 row_newbcast:8 row_mask:0xf bank_mask:0xf
v_and_b32_dpp v163, v25, v11 row_newbcast:8 row_mask:0xf bank_mask:0xf
v_mov_b64 v[128:129], 0
v_mov_b64 v[130:131], 0
s_waitcnt vmcnt(1)
v_mfma_f32_16x16x32_bf16 v[28:31], v[152:155], v[160:163], v[28:31]
v_and_b32_dpp v164, v25, v8 row_newbcast:12 row_mask:0xf bank_mask:0xf
v_and_b32_dpp v165, v25, v9 row_newbcast:12 row_mask:0xf bank_mask:0xf
v_and_b32_dpp v166, v25, v10 row_newbcast:12 row_mask:0xf bank_mask:0xf
v_and_b32_dpp v167, v25, v11 row_newbcast:12 row_mask:0xf bank_mask:0xf
s_waitcnt vmcnt(0)
s_nop 0
v_mfma_f32_16x16x32_bf16 v[28:31], v[156:159], v[164:167], v[28:31]
s_nop 7
v_cvt_pk_bf16_f32 v28, v28, v29
v_cvt_pk_bf16_f32 v29, v30, v31
s_mov_b32 exec_lo, 0x00ff00ff
s_mov_b32 exec_hi, 0x00ff00ff
ds_write2_b32 v18, v28, v29 offset0:0 offset1:32
s_mov_b64 exec, -1
s_waitcnt lgkmcnt(0)
s_barrier
ds_read_b128 v[96:99], v19 offset:0
ds_read_b128 v[100:103], v19 offset:64
ds_read_b128 v[112:115], v21 offset:2240
s_waitcnt lgkmcnt(2)
v_smfmac_f32_16x16x64_bf16 v[116:119], v[96:99], v[32:39], v104
v_smfmac_f32_16x16x64_bf16 v[120:123], v[96:99], v[40:47], v104
v_smfmac_f32_16x16x64_bf16 v[124:127], v[96:99], v[48:55], v104
v_smfmac_f32_16x16x64_bf16 v[128:131], v[96:99], v[56:63], v104
s_waitcnt lgkmcnt(1)
v_smfmac_f32_16x16x64_bf16 v[116:119], v[100:103], v[64:71], v104
v_smfmac_f32_16x16x64_bf16 v[120:123], v[100:103], v[72:79], v104
v_smfmac_f32_16x16x64_bf16 v[124:127], v[100:103], v[80:87], v104
v_smfmac_f32_16x16x64_bf16 v[128:131], v[100:103], v[88:95], v104
s_waitcnt lgkmcnt(0)
s_nop 3
v_pk_mul_f32 v[136:137], v[112:113], v[116:117]
v_pk_fma_f32 v[136:137], v[114:115], v[118:119], v[136:137]
v_pk_mul_f32 v[138:139], v[112:113], v[120:121]
v_pk_fma_f32 v[138:139], v[114:115], v[122:123], v[138:139]
v_pk_mul_f32 v[140:141], v[112:113], v[124:125]
v_pk_fma_f32 v[140:141], v[114:115], v[126:127], v[140:141]
v_pk_mul_f32 v[142:143], v[112:113], v[128:129]
v_pk_fma_f32 v[142:143], v[114:115], v[130:131], v[142:143]
v_add_f32 v132, v136, v137
v_add_f32 v134, v140, v141
v_add_f32 v133, v138, v139
v_add_f32 v135, v142, v143
v_permlane16_swap_b32 v132, v134
s_nop 0
v_permlane16_swap_b32 v133, v135
v_add_f32 v132, v132, v134
v_add_f32 v133, v133, v135
s_nop 1
v_permlane32_swap_b32 v132, v133
v_add_f32 v132, v132, v133
v_cndmask_b32 v133, v132, 1.0, s[34:35]
buffer_atomic_add_f32 v133, v16, s[64:67], s5 offen sc1
v_cndmask_b32 v134, 1.0, v132, s[34:35]
buffer_atomic_add_f32 v134, v17, s[64:67], s5 offen offset:64 sc1
s_waitcnt lgkmcnt(0)
s_endpgm
L_helpers:
s_cmp_eq_u32 s3, 1
s_cbranch_scc1 L_H1
L_H0:
v_lshlrev_b32 v14, 3, v0
v_mov_b32 v20, 0
v_mov_b32 v21, 0
ds_write_b64 v14, v[20:21] offset:2176
s_lshl_b32 s43, s42, 7
v_lshlrev_b32 v19, 13, v2
v_lshl_add_u32 v19, v3, 4, v19
s_lshl_b32 s4, s42, 19
s_lshl_b32 s5, s41, 8
s_add_u32 s4, s4, s5
s_waitcnt lgkmcnt(0)
s_mov_b32 s52, s8
s_and_b32 s53, s9, 0xffff
s_mov_b32 s54, 0x800
s_mov_b32 s55, 0x20000
v_lshlrev_b32 v1, 4, v0
v_lshl_add_u32 v14, v3, 2, v2
v_lshlrev_b32 v14, 1, v14
buffer_load_dwordx4 v[4:7], v1, s[52:55], 0 offen
buffer_load_dwordx4 v[8:11], v1, s[52:55], 0 offen offset:1024
buffer_load_ushort v12, v14, s[52:55], s43 offen
buffer_load_ushort v13, v14, s[52:55], s43 offen offset:1024
s_load_dword s32, s[30:31], 0
s_mov_b32 s56, s14
s_and_b32 s57, s15, 0xffff
s_mov_b32 s58, 0x400000
s_mov_b32 s59, 0x20000
v_mov_b32 v155, v19
s_mov_b32 s101, s4
s_add_u32 s60, s4, 0
buffer_load_dwordx4 v[32:35], v155, s[56:59], s60 offen nt
s_add_u32 s61, s4, 32768
buffer_load_dwordx4 v[36:39], v155, s[56:59], s61 offen nt
s_add_u32 s60, s4, 65536
buffer_load_dwordx4 v[40:43], v155, s[56:59], s60 offen nt
s_add_u32 s61, s4, 98304
buffer_load_dwordx4 v[44:47], v155, s[56:59], s61 offen nt
s_add_u32 s60, s4, 131072
buffer_load_dwordx4 v[48:51], v155, s[56:59], s60 offen nt
s_add_u32 s61, s4, 163840
buffer_load_dwordx4 v[52:55], v155, s[56:59], s61 offen nt
s_add_u32 s60, s4, 196608
buffer_load_dwordx4 v[56:59], v155, s[56:59], s60 offen nt
s_add_u32 s61, s4, 229376
buffer_load_dwordx4 v[60:63], v155, s[56:59], s61 offen nt
s_add_u32 s60, s4, 262144
buffer_load_dwordx4 v[64:67], v155, s[56:59], s60 offen nt
s_add_u32 s61, s4, 294912
buffer_load_dwordx4 v[68:71], v155, s[56:59], s61 offen nt
s_add_u32 s60, s4, 327680
buffer_load_dwordx4 v[72:75], v155, s[56:59], s60 offen nt
s_add_u32 s61, s4, 360448
buffer_load_dwordx4 v[76:79], v155, s[56:59], s61 offen nt
s_add_u32 s60, s4, 393216
buffer_load_dwordx4 v[80:83], v155, s[56:59], s60 offen nt
s_add_u32 s61, s4, 425984
buffer_load_dwordx4 v[84:87], v155, s[56:59], s61 offen nt
s_add_u32 s60, s4, 458752
buffer_load_dwordx4 v[88:91], v155, s[56:59], s60 offen nt
s_add_u32 s61, s4, 491520
buffer_load_dwordx4 v[92:95], v155, s[56:59], s61 offen nt
s_barrier
s_mov_b32 s64, s30
s_and_b32 s65, s31, 0xffff
s_mov_b32 s66, 0x130000
s_mov_b32 s67, 0x20000
s_mov_b32 s80, s26
s_and_b32 s81, s27, 0xffff
s_mov_b32 s82, 0x800
s_mov_b32 s83, 0x20000
v_mov_b32 v20, 0
v_mov_b32 v21, 0
v_and_b32 v24, 7, v3
v_and_b32 v25, 1, v24
v_lshlrev_b32 v25, 4, v25
v_mov_b32 v26, 0xffff
v_lshlrev_b32 v25, v25, v26
v_lshrrev_b32 v26, 1, v24
v_cmp_eq_u32 vcc, 0, v26
s_nop 1
v_cndmask_b32 v128, 0, v25, vcc
v_cmp_eq_u32 vcc, 1, v26
s_nop 1
v_cndmask_b32 v129, 0, v25, vcc
v_cmp_eq_u32 vcc, 2, v26
s_nop 1
v_cndmask_b32 v130, 0, v25, vcc
v_cmp_eq_u32 vcc, 3, v26
s_nop 1
v_cndmask_b32 v131, 0, v25, vcc
v_mov_b32 v26, 0xff
s_waitcnt vmcnt(16)
s_mov_b32 s4, 0x3f803f80
v_dot2_f32_bf16 v14, v4, s4, 0
v_dot2_f32_bf16 v15, v8, s4, 0
v_dot2_f32_bf16 v14, v5, s4, v14
v_dot2_f32_bf16 v15, v9, s4, v15
v_dot2_f32_bf16 v14, v6, s4, v14
v_dot2_f32_bf16 v15, v10, s4, v15
v_dot2_f32_bf16 v14, v7, s4, v14
v_dot2_f32_bf16 v15, v11, s4, v15
s_nop 1
v_add_f32_dpp v16, v14, v14 row_ror:8 row_mask:0xf bank_mask:0x3
s_nop 1
v_add_f32_dpp v16, v15, v15 row_ror:8 row_mask:0xf bank_mask:0xc
s_nop 1
v_add_f32_dpp v16, v16, v16 row_half_mirror row_mask:0xf bank_mask:0xf
s_nop 1
v_add_f32_dpp v16, v16, v16 quad_perm:[1,0,3,2] row_mask:0xf bank_mask:0xf
s_nop 1
v_add_f32_dpp v16, v16, v16 quad_perm:[2,3,0,1] row_mask:0xf bank_mask:0xf
v_mov_b32 v17, v16
s_nop 1
v_permlane16_swap_b32 v16, v17
v_add_f32 v16, v16, v17
v_mov_b32 v17, v16
s_nop 1
v_permlane32_swap_b32 v16, v17
v_add_f32 v16, v16, v17
v_mul_f32 v16, 0x3b000000, v16
s_nop 0
v_readlane_b32 s4, v16, 0
v_readlane_b32 s5, v16, 8
v_cvt_pk_bf16_f32 v18, v16, v16
v_and_b32 v18, 0xffff0000, v18
v_lshlrev_b32 v20, 16, v4
v_and_b32 v21, 0xffff0000, v4
v_subrev_f32 v20, s4, v20
v_subrev_f32 v21, s4, v21
v_mul_f32 v14, v20, v20
v_fmac_f32 v14, v21, v21
v_lshlrev_b32 v22, 16, v8
v_and_b32 v23, 0xffff0000, v8
v_subrev_f32 v22, s5, v22
v_subrev_f32 v23, s5, v23
v_mul_f32 v15, v22, v22
v_fmac_f32 v15, v23, v23
v_lshlrev_b32 v20, 16, v5
v_and_b32 v21, 0xffff0000, v5
v_subrev_f32 v20, s4, v20
v_subrev_f32 v21, s4, v21
v_fmac_f32 v14, v20, v20
v_fmac_f32 v14, v21, v21
v_lshlrev_b32 v22, 16, v9
v_and_b32 v23, 0xffff0000, v9
v_subrev_f32 v22, s5, v22
v_subrev_f32 v23, s5, v23
v_fmac_f32 v15, v22, v22
v_fmac_f32 v15, v23, v23
v_lshlrev_b32 v20, 16, v6
v_and_b32 v21, 0xffff0000, v6
v_subrev_f32 v20, s4, v20
v_subrev_f32 v21, s4, v21
v_fmac_f32 v14, v20, v20
v_fmac_f32 v14, v21, v21
v_lshlrev_b32 v22, 16, v10
v_and_b32 v23, 0xffff0000, v10
v_subrev_f32 v22, s5, v22
v_subrev_f32 v23, s5, v23
v_fmac_f32 v15, v22, v22
v_fmac_f32 v15, v23, v23
v_lshlrev_b32 v20, 16, v7
v_and_b32 v21, 0xffff0000, v7
v_subrev_f32 v20, s4, v20
v_subrev_f32 v21, s4, v21
v_fmac_f32 v14, v20, v20
v_fmac_f32 v14, v21, v21
v_lshlrev_b32 v22, 16, v11
v_and_b32 v23, 0xffff0000, v11
v_subrev_f32 v22, s5, v22
v_subrev_f32 v23, s5, v23
v_fmac_f32 v15, v22, v22
v_fmac_f32 v15, v23, v23
v_add_f32_dpp v16, v14, v14 row_ror:8 row_mask:0xf bank_mask:0x3
s_nop 1
v_add_f32_dpp v16, v15, v15 row_ror:8 row_mask:0xf bank_mask:0xc
s_nop 1
v_add_f32_dpp v16, v16, v16 row_half_mirror row_mask:0xf bank_mask:0xf
s_nop 1
v_add_f32_dpp v16, v16, v16 quad_perm:[1,0,3,2] row_mask:0xf bank_mask:0xf
s_nop 1
v_add_f32_dpp v16, v16, v16 quad_perm:[2,3,0,1] row_mask:0xf bank_mask:0xf
v_mov_b32 v17, v16
s_nop 1
v_permlane16_swap_b32 v16, v17
v_add_f32 v16, v16, v17
v_mov_b32 v17, v16
s_nop 1
v_permlane32_swap_b32 v16, v17
v_add_f32 v16, v16, v17
v_mul_f32 v16, 0x3b000000, v16
v_cvt_pk_bf16_f32 v16, v16, v16
v_and_b32 v16, 0xffff0000, v16
v_add_f32 v16, 0x3727c5ac, v16
v_cvt_pk_bf16_f32 v16, v16, v16
v_and_b32 v16, 0xffff0000, v16
v_sqrt_f32 v16, v16
s_nop 0
v_cvt_pk_bf16_f32 v16, v16, v16
v_and_b32 v16, 0xffff0000, v16
v_rcp_f32 v17, v16
v_readlane_b32 s4, v18, 0
v_readlane_b32 s5, v18, 8
v_readlane_b32 s6, v16, 0
v_readlane_b32 s7, v16, 8
v_readlane_b32 s38, v17, 0
v_readlane_b32 s40, v17, 8
v_lshlrev_b32 v12, 16, v12
v_subrev_f32 v12, s4, v12
v_cvt_pk_bf16_f32 v12, v12, v12
v_and_b32 v12, 0xffff0000, v12
v_mul_f32 v20, s38, v12
v_fma_f32 v21, -v20, s6, v12
v_fma_f32 v20, v21, s38, v20
v_cvt_pk_bf16_f32 v12, v20, v20
v_lshlrev_b32 v13, 16, v13
v_subrev_f32 v13, s5, v13
v_cvt_pk_bf16_f32 v13, v13, v13
v_and_b32 v13, 0xffff0000, v13
v_mul_f32 v22, s40, v13
v_fma_f32 v23, -v22, s7, v13
v_fma_f32 v22, v23, s40, v22
v_cvt_pk_bf16_f32 v13, v22, v22
v_lshlrev_b32 v14, 6, v2
v_lshl_add_u32 v15, v3, 2, v14
ds_write_b32 v15, v12 offset:2816
ds_write_b32 v15, v13 offset:3072
v_lshrrev_b32 v15, 3, v3
v_lshl_add_u32 v15, v15, 8, v14
ds_read_b128 v[96:99], v15 offset:2816
ds_read_b128 v[100:103], v15 offset:2832
ds_read_b128 v[104:107], v15 offset:2848
ds_read_b128 v[108:111], v15 offset:2864
v_lshrrev_b32 v152, 3, v3
v_lshlrev_b32 v152, 12, v152
v_lshl_add_u32 v152, v2, 7, v152
v_lshl_add_u32 v152, v24, 4, v152
s_waitcnt lgkmcnt(0)
s_add_u32 s32, s32, 0x10010101
s_and_b32 s33, s32, 0xff
s_bfe_u32 s34, s32, 0x80008
s_bfe_u32 s35, s32, 0x80010
s_lshr_b32 s36, s32, 24
s_getreg_b32 s100, hwreg(HW_REG_XCC_ID, 0, 4)
s_and_b32 s18, s36, 0xf0
s_or_b32 s100, s100, s18
s_and_b32 s37, s32, 0xffff
s_lshr_b32 s18, s32, 16
s_lshl_b32 s4, s41, 13
s_lshl_b32 s5, s42, 9
s_add_u32 s5, s5, s4
s_add_u32 s76, s5, 0xc0000
s_lshr_b32 s6, s42, 2
s_lshl_b32 s6, s6, 12
s_add_u32 s6, s6, s4
s_add_u32 s19, s6, 0xc0000
v_and_b32 v112, v96, v128
v_and_b32 v113, v96, v129
v_and_b32 v114, v96, v130
v_and_b32 v115, v96, v131
v_and_b32 v116, v97, v128
v_and_b32 v117, v97, v129
v_and_b32 v118, v97, v130
v_and_b32 v119, v97, v131
s_waitcnt vmcnt(15)
v_mfma_f32_16x16x32_bf16 v[132:135], v[32:35], v[112:115], 0
v_and_b32 v120, v98, v128
v_and_b32 v121, v98, v129
v_and_b32 v122, v98, v130
v_and_b32 v123, v98, v131
s_waitcnt vmcnt(14)
v_mfma_f32_16x16x32_bf16 v[132:135], v[36:39], v[116:119], v[132:135]
v_and_b32 v124, v99, v128
v_and_b32 v125, v99, v129
v_and_b32 v126, v99, v130
v_and_b32 v127, v99, v131
s_waitcnt vmcnt(13)
v_mfma_f32_16x16x32_bf16 v[132:135], v[40:43], v[120:123], v[132:135]
v_and_b32 v112, v100, v128
v_and_b32 v113, v100, v129
v_and_b32 v114, v100, v130
v_and_b32 v115, v100, v131
s_waitcnt vmcnt(12)
v_mfma_f32_16x16x32_bf16 v[132:135], v[44:47], v[124:127], v[132:135]
v_and_b32 v116, v101, v128
v_and_b32 v117, v101, v129
v_and_b32 v118, v101, v130
v_and_b32 v119, v101, v131
s_waitcnt vmcnt(11)
v_mfma_f32_16x16x32_bf16 v[132:135], v[48:51], v[112:115], v[132:135]
v_and_b32 v120, v102, v128
v_and_b32 v121, v102, v129
v_and_b32 v122, v102, v130
v_and_b32 v123, v102, v131
s_waitcnt vmcnt(10)
v_mfma_f32_16x16x32_bf16 v[132:135], v[52:55], v[116:119], v[132:135]
v_and_b32 v124, v103, v128
v_and_b32 v125, v103, v129
v_and_b32 v126, v103, v130
v_and_b32 v127, v103, v131
s_waitcnt vmcnt(9)
v_mfma_f32_16x16x32_bf16 v[132:135], v[56:59], v[120:123], v[132:135]
v_and_b32 v112, v104, v128
v_and_b32 v113, v104, v129
v_and_b32 v114, v104, v130
v_and_b32 v115, v104, v131
s_waitcnt vmcnt(8)
v_mfma_f32_16x16x32_bf16 v[132:135], v[60:63], v[124:127], v[132:135]
v_and_b32 v116, v105, v128
v_and_b32 v117, v105, v129
v_and_b32 v118, v105, v130
v_and_b32 v119, v105, v131
s_waitcnt vmcnt(7)
v_mfma_f32_16x16x32_bf16 v[132:135], v[64:67], v[112:115], v[132:135]
v_and_b32 v120, v106, v128
v_and_b32 v121, v106, v129
v_and_b32 v122, v106, v130
v_and_b32 v123, v106, v131
s_waitcnt vmcnt(6)
v_mfma_f32_16x16x32_bf16 v[132:135], v[68:71], v[116:119], v[132:135]
v_and_b32 v124, v107, v128
v_and_b32 v125, v107, v129
v_and_b32 v126, v107, v130
v_and_b32 v127, v107, v131
s_waitcnt vmcnt(5)
v_mfma_f32_16x16x32_bf16 v[132:135], v[72:75], v[120:123], v[132:135]
v_and_b32 v112, v108, v128
v_and_b32 v113, v108, v129
v_and_b32 v114, v108, v130
v_and_b32 v115, v108, v131
s_waitcnt vmcnt(4)
v_mfma_f32_16x16x32_bf16 v[132:135], v[76:79], v[124:127], v[132:135]
v_and_b32 v116, v109, v128
v_and_b32 v117, v109, v129
v_and_b32 v118, v109, v130
v_and_b32 v119, v109, v131
s_waitcnt vmcnt(3)
v_mfma_f32_16x16x32_bf16 v[132:135], v[80:83], v[112:115], v[132:135]
v_and_b32 v120, v110, v128
v_and_b32 v121, v110, v129
v_and_b32 v122, v110, v130
v_and_b32 v123, v110, v131
s_waitcnt vmcnt(2)
v_mfma_f32_16x16x32_bf16 v[132:135], v[84:87], v[116:119], v[132:135]
v_and_b32 v124, v111, v128
v_and_b32 v125, v111, v129
v_and_b32 v126, v111, v130
v_and_b32 v127, v111, v131
s_waitcnt vmcnt(1)
v_mfma_f32_16x16x32_bf16 v[132:135], v[88:91], v[120:123], v[132:135]
s_waitcnt vmcnt(0)
v_mfma_f32_16x16x32_bf16 v[132:135], v[92:95], v[124:127], v[132:135]
s_nop 7
v_bfi_b32 v132, v26, s33, v132
v_bfi_b32 v133, v26, s34, v133
v_bfi_b32 v134, v26, s35, v134
v_bfi_b32 v135, v26, s100, v135
buffer_store_dwordx4 v[132:135], v152, s[64:67], s76 offen
v_bfe_u32 v14, v0, 3, 2
v_lshlrev_b32 v14, 6, v14
v_lshrrev_b32 v15, 5, v0
v_lshl_add_u32 v14, v15, 4, v14
v_lshl_add_u32 v27, v24, 1, v14
s_lshr_b32 s7, s42, 2
s_lshl_b32 s7, s7, 5
s_add_u32 s7, s7, s41
s_lshl_b32 s7, s7, 8
s_add_u32 s77, s7, 0x4000
s_and_b32 s4, s42, 3
s_lshl_b32 s4, s4, 4
s_add_u32 s7, s77, s4
s_lshl_b32 s79, s2, 4
s_add_u32 s79, s79, 0x3000
v_and_b32 v24, 7, v0
v_lshlrev_b32 v18, 3, v24
v_lshlrev_b32 v19, 2, v24
v_mov_b32 v15, 0
v_mov_b32 v10, s18
v_mov_b32 v11, 0
s_sub_u32 s43, s2, 192
s_bfe_u32 s5, s43, 0x10005
s_and_b32 s6, s43, 31
s_lshl_b32 s4, s5, 18
s_lshl_b32 s38, s6, 6
s_add_u32 s4, s4, s38
s_add_u32 s68, s4, 0x10000
s_add_u32 s69, s4, 0x18000
s_add_u32 s70, s4, 0x20000
s_add_u32 s71, s4, 0x28000
s_add_u32 s72, s4, 0x30000
s_add_u32 s73, s4, 0x38000
s_add_u32 s74, s4, 0x40000
s_add_u32 s75, s4, 0x48000
s_lshl_b32 s4, s5, 10
s_lshr_b32 s38, s6, 1
s_lshl_b32 s38, s38, 6
s_add_u32 s4, s4, s38
s_and_b32 s38, s6, 1
s_lshl_b32 s38, s38, 3
s_add_u32 s42, s4, s38
v_and_b32 v22, 3, v0
v_lshlrev_b32 v153, 4, v22
v_lshlrev_b32 v21, 4, v2
v_lshl_add_u32 v21, v22, 1, v21
v_lshl_add_u32 v25, v2, 2, v22
v_lshlrev_b32 v25, 3, v25
v_lshrrev_b32 v23, 2, v0
v_lshlrev_b32 v23, 11, v23
v_lshl_add_u32 v23, v22, 4, v23
v_lshrrev_b32 v21, 2, v3
v_lshlrev_b32 v21, 4, v21
v_lshl_add_u32 v21, v22, 1, v21
v_lshlrev_b32 v25, 3, v3
v_and_b32 v23, 1, v3
v_lshlrev_b32 v23, 6, v23
v_lshl_add_u32 v23, v2, 13, v23
v_lshrrev_b32 v14, 1, v3
v_lshl_add_u32 v23, v14, 3, v23
s_lshl_b32 s68, s43, 7
s_add_u32 s68, s68, 0x10000
v_lshlrev_b32 v156, 2, v0
s_mov_b32 s69, 0x2000
s_cmp_lt_u32 s2, 192
s_cbranch_scc1 L_h0_nox
buffer_load_ushort v20, v21, s[52:55], s42 offen
buffer_load_ushort v154, v21, s[80:83], s42 offen
L_h0_nox:
s_mov_b64 s[44:45], -1
s_mov_b64 s[46:47], -1
s_mov_b64 s[48:49], -1
s_mov_b64 s[50:51], -1
s_mov_b64 s[56:57], -1
s_mov_b64 s[58:59], -1
s_mov_b64 s[60:61], -1
s_mov_b64 s[62:63], -1
v_mov_b32 v28, 0
v_mov_b32 v29, 0
v_mov_b32 v30, 0
v_mov_b32 v31, 0
s_mov_b32 s78, 0
L_h0_fg:
ds_read_b32 v14, v18 offset:2432
s_waitcnt lgkmcnt(0)
v_cmp_ne_u32 vcc, 0, v14
s_bcnt1_i32_b64 s40, vcc
s_cmp_ge_u32 s40, 64
s_cbranch_scc1 L_h0_fg_ok
s_sub_u32 s39, s39, 1
s_cbranch_scc1 L_timeout
s_branch L_h0_fg
L_h0_fg_ok:
buffer_load_dwordx4 v[136:139], v1, s[64:67], s19 offen offset:0 sc1
buffer_load_dwordx4 v[140:143], v1, s[64:67], s19 offen offset:1024 sc1
buffer_load_dwordx4 v[144:147], v1, s[64:67], s19 offen offset:2048 sc1
buffer_load_dwordx4 v[148:151], v1, s[64:67], s19 offen offset:3072 sc1
s_waitcnt vmcnt(0)
v_xor_b32 v136, s33, v136
v_xor_b32 v137, s34, v137
v_xor_b32 v138, s35, v138
v_xor_b32 v139, s100, v139
v_xor_b32 v140, s33, v140
v_xor_b32 v141, s34, v141
v_xor_b32 v142, s35, v142
v_xor_b32 v143, s100, v143
v_xor_b32 v144, s33, v144
v_xor_b32 v145, s34, v145
v_xor_b32 v146, s35, v146
v_xor_b32 v147, s100, v147
v_xor_b32 v148, s33, v148
v_xor_b32 v149, s34, v149
v_xor_b32 v150, s35, v150
v_xor_b32 v151, s100, v151
v_or3_b32 v14, v136, v137, v138
v_or3_b32 v14, v14, v139, v140
v_or3_b32 v14, v14, v141, v142
v_or3_b32 v14, v14, v143, v144
v_or3_b32 v14, v14, v145, v146
v_or3_b32 v14, v14, v147, v148
v_or3_b32 v14, v14, v149, v150
v_or_b32 v14, v14, v151
v_and_b32 v14, 0xff, v14
v_cmp_ne_u32 vcc, 0, v14
s_cbranch_vccz L_h0_q_ok
buffer_store_dwordx4 v[132:135], v152, s[64:67], s76 offen sc1
s_mov_b32 s78, 1
L_h0_q:
s_sub_u32 s39, s39, 1
s_cbranch_scc1 L_timeout
buffer_load_dwordx4 v[136:139], v1, s[64:67], s19 offen offset:0 sc1
buffer_load_dwordx4 v[140:143], v1, s[64:67], s19 offen offset:1024 sc1
buffer_load_dwordx4 v[144:147], v1, s[64:67], s19 offen offset:2048 sc1
buffer_load_dwordx4 v[148:151], v1, s[64:67], s19 offen offset:3072 sc1
s_waitcnt vmcnt(0)
v_xor_b32 v136, s33, v136
v_xor_b32 v137, s34, v137
v_xor_b32 v138, s35, v138
v_xor_b32 v139, s100, v139
v_xor_b32 v140, s33, v140
v_xor_b32 v141, s34, v141
v_xor_b32 v142, s35, v142
v_xor_b32 v143, s100, v143
v_xor_b32 v144, s33, v144
v_xor_b32 v145, s34, v145
v_xor_b32 v146, s35, v146
v_xor_b32 v147, s100, v147
v_xor_b32 v148, s33, v148
v_xor_b32 v149, s34, v149
v_xor_b32 v150, s35, v150
v_xor_b32 v151, s100, v151
v_or3_b32 v14, v139, v143, v147
v_or_b32 v14, v14, v151
v_and_b32 v14, 0xf0, v14
v_or3_b32 v14, v14, v136, v137
v_or3_b32 v14, v14, v138, v140
v_or3_b32 v14, v14, v141, v142
v_or3_b32 v14, v14, v144, v145
v_or3_b32 v14, v14, v146, v148
v_or3_b32 v14, v14, v149, v150
v_and_b32 v14, 0xff, v14
v_cmp_ne_u32 vcc, 0, v14
s_cbranch_vccnz L_h0_q
L_h0_q_ok:
v_add_f32 v136, v136, v140
v_add_f32 v144, v144, v148
v_add_f32 v137, v137, v141
v_add_f32 v145, v145, v149
v_add_f32 v138, v138, v142
v_add_f32 v146, v146, v150
v_add_f32 v139, v139, v143
v_add_f32 v147, v147, v151
v_add_f32 v136, v136, v144
v_add_f32 v137, v137, v145
v_add_f32 v138, v138, v146
v_add_f32 v139, v139, v147
v_permlane32_swap_b32 v136, v137
s_nop 0
v_permlane32_swap_b32 v138, v139
v_add_f32 v136, v136, v137
v_add_f32 v138, v138, v139
v_cvt_pk_bf16_f32 v136, v136, v136
v_cvt_pk_bf16_f32 v138, v138, v138
ds_write_b16 v27, v136 offset:3840
ds_write_b16 v27, v138 offset:3872
ds_write_b32 v19, v26 offset:2496
s_waitcnt lgkmcnt(0)
buffer_load_dword v157, v156, s[64:67], s69 offen sc1
L_h0_zf:
s_waitcnt vmcnt(0)
v_cmp_ne_u32 vcc, s32, v157
s_cbranch_vccz L_h0_zf_ok
s_sub_u32 s39, s39, 1
s_cbranch_scc1 L_timeout
buffer_load_dword v157, v156, s[64:67], s69 offen sc1
s_branch L_h0_zf
L_h0_zf_ok:
L_h0_p:
ds_read_b64 v[12:13], v18 offset:2176
s_waitcnt lgkmcnt(0)
v_cmp_eq_u32 vcc, 0, v13
s_cbranch_vccz L_h0_p_ok
s_sub_u32 s39, s39, 1
s_cbranch_scc1 L_timeout
s_branch L_h0_p
L_h0_p_ok:
v_max_f32_dpp v14, v12, v12 row_half_mirror row_mask:0xf bank_mask:0xf
s_nop 1
v_max_f32_dpp v14, v14, v14 quad_perm:[1,0,3,2] row_mask:0xf bank_mask:0xf
s_nop 1
v_max_f32_dpp v16, v14, v14 quad_perm:[2,3,0,1] row_mask:0xf bank_mask:0xf
v_sub_f32 v12, v12, v16
v_mul_f32 v12, 0x3fb8aa3b, v12
v_exp_f32 v12, v12
v_or_b32 v8, s37, v16
v_mul_f32 v9, v12, v13
s_nop 1
v_add_f32_dpp v9, v9, v9 row_half_mirror row_mask:0xf bank_mask:0xf
s_nop 1
v_add_f32_dpp v9, v9, v9 quad_perm:[1,0,3,2] row_mask:0xf bank_mask:0xf
s_nop 1
v_add_f32_dpp v9, v9, v9 quad_perm:[2,3,0,1] row_mask:0xf bank_mask:0xf
s_mov_b64 exec, 1
s_cmp_eq_u32 s78, 0
s_cbranch_scc1 L_h0_mll
buffer_store_dwordx4 v[8:11], v15, s[64:67], s7 offen sc1
s_branch L_h0_mlp
L_h0_mll:
buffer_store_dwordx4 v[8:11], v15, s[64:67], s7 offen
L_h0_mlp:
buffer_store_dwordx4 v[8:11], v15, s[64:67], s79 offen sc1
s_mov_b64 exec, -1
L_h0_ml:
buffer_load_dwordx4 v[64:67], v153, s[64:67], s77 offen sc1
s_waitcnt vmcnt(0)
v_xor_b32 v64, s37, v64
v_xor_b32 v66, s18, v66
v_or_b32 v15, v64, v66
v_and_b32 v15, 0xffff, v15
v_cmp_ne_u32 vcc, 0, v15
s_cbranch_vccz L_h0_ml_ok
s_sub_u32 s39, s39, 1
s_cbranch_scc1 L_timeout
s_branch L_h0_ml
L_h0_ml_ok:
v_max_f32_dpp v14, v64, v64 quad_perm:[1,0,3,2] row_mask:0xf bank_mask:0xf
s_nop 1
v_max_f32_dpp v14, v14, v14 quad_perm:[2,3,0,1] row_mask:0xf bank_mask:0xf
v_sub_f32 v64, v64, v14
v_sub_f32 v16, v16, v14
v_mul_f32 v64, 0x3fb8aa3b, v64
v_mul_f32 v16, 0x3fb8aa3b, v16
v_exp_f32 v64, v64
v_exp_f32 v16, v16
v_mul_f32 v65, v64, v65
v_mul_f32 v12, v12, v16
s_nop 0
v_add_f32_dpp v65, v65, v65 quad_perm:[1,0,3,2] row_mask:0xf bank_mask:0xf
s_nop 1
v_add_f32_dpp v65, v65, v65 quad_perm:[2,3,0,1] row_mask:0xf bank_mask:0xf
v_rcp_f32 v65, v65
s_nop 0
v_mul_f32 v12, v12, v65
ds_write_b32 v19, v12 offset:2240
s_waitcnt lgkmcnt(0)
s_cmp_ge_u32 s2, 192
s_cbranch_scc1 L_h0_cons
s_waitcnt lgkmcnt(0)
s_endpgm
L_h0_cons:
v_mov_b32 v32, 0
v_mov_b32 v33, 0
v_mov_b32 v34, 0
v_mov_b32 v35, 0
v_mov_b32 v36, 0
v_mov_b32 v37, 0
v_mov_b32 v38, 0
v_mov_b32 v39, 0
v_mov_b32 v40, 0
v_mov_b32 v41, 0
v_mov_b32 v42, 0
v_mov_b32 v43, 0
v_mov_b32 v17, 0
s_barrier
buffer_atomic_or_x2 v[32:33], v23, s[64:67], s68 offen sc0 sc1
ds_read_b64 v[16:17], v25 offset:2304
s_waitcnt lgkmcnt(0)
buffer_atomic_or_x2 v[34:35], v23, s[64:67], s68 offen sc0 sc1
ds_read_b64 v[16:17], v25 offset:2304
s_waitcnt lgkmcnt(0)
buffer_atomic_or_x2 v[36:37], v23, s[64:67], s68 offen sc0 sc1
ds_read_b64 v[16:17], v25 offset:2304
s_waitcnt lgkmcnt(0)
buffer_atomic_or_x2 v[38:39], v23, s[64:67], s68 offen sc0 sc1
ds_read_b64 v[16:17], v25 offset:2304
s_waitcnt lgkmcnt(0)
buffer_atomic_or_x2 v[40:41], v23, s[64:67], s68 offen sc0 sc1
ds_read_b64 v[16:17], v25 offset:2304
s_waitcnt lgkmcnt(0)
buffer_atomic_or_x2 v[42:43], v23, s[64:67], s68 offen sc0 sc1
ds_read_b64 v[16:17], v25 offset:2304
s_waitcnt lgkmcnt(0)
v_lshlrev_b32 v20, 16, v20
s_mov_b32 s40, 0x42000000
L_h0_y:
s_waitcnt vmcnt(5)
v_mov_b32 v28, v32
v_mov_b32 v29, v32
v_cmp_ne_u32 vcc, s40, v33
s_cbranch_vccz L_h0_y_ok
v_mov_b32 v32, 0
v_mov_b32 v33, 0
buffer_atomic_or_x2 v[32:33], v23, s[64:67], s68 offen sc0 sc1
ds_read_b64 v[16:17], v25 offset:2304
s_waitcnt lgkmcnt(0)
s_waitcnt vmcnt(5)
v_mov_b32 v28, v34
v_mov_b32 v29, v34
v_cmp_ne_u32 vcc, s40, v35
s_cbranch_vccz L_h0_y_ok
v_mov_b32 v34, 0
v_mov_b32 v35, 0
buffer_atomic_or_x2 v[34:35], v23, s[64:67], s68 offen sc0 sc1
ds_read_b64 v[16:17], v25 offset:2304
s_waitcnt lgkmcnt(0)
s_waitcnt vmcnt(5)
v_mov_b32 v28, v36
v_mov_b32 v29, v36
v_cmp_ne_u32 vcc, s40, v37
s_cbranch_vccz L_h0_y_ok
v_mov_b32 v36, 0
v_mov_b32 v37, 0
buffer_atomic_or_x2 v[36:37], v23, s[64:67], s68 offen sc0 sc1
ds_read_b64 v[16:17], v25 offset:2304
s_waitcnt lgkmcnt(0)
s_waitcnt vmcnt(5)
v_mov_b32 v28, v38
v_mov_b32 v29, v38
v_cmp_ne_u32 vcc, s40, v39
s_cbranch_vccz L_h0_y_ok
v_mov_b32 v38, 0
v_mov_b32 v39, 0
buffer_atomic_or_x2 v[38:39], v23, s[64:67], s68 offen sc0 sc1
ds_read_b64 v[16:17], v25 offset:2304
s_waitcnt lgkmcnt(0)
s_waitcnt vmcnt(5)
v_mov_b32 v28, v40
v_mov_b32 v29, v40
v_cmp_ne_u32 vcc, s40, v41
s_cbranch_vccz L_h0_y_ok
v_mov_b32 v40, 0
v_mov_b32 v41, 0
buffer_atomic_or_x2 v[40:41], v23, s[64:67], s68 offen sc0 sc1
ds_read_b64 v[16:17], v25 offset:2304
s_waitcnt lgkmcnt(0)
s_waitcnt vmcnt(5)
v_mov_b32 v28, v42
v_mov_b32 v29, v42
v_cmp_ne_u32 vcc, s40, v43
s_cbranch_vccz L_h0_y_ok
v_mov_b32 v42, 0
v_mov_b32 v43, 0
buffer_atomic_or_x2 v[42:43], v23, s[64:67], s68 offen sc0 sc1
ds_read_b64 v[16:17], v25 offset:2304
s_waitcnt lgkmcnt(0)
s_sub_u32 s39, s39, 1
s_cbranch_scc1 L_timeout
s_branch L_h0_y
L_h0_y_ok:
v_permlane16_swap_b32 v28, v29
v_add_f32 v28, v28, v29
v_mov_b32 v29, v28
s_nop 1
v_permlane32_swap_b32 v28, v29
v_add_f32 v28, v28, v29
L_h0_g:
s_waitcnt lgkmcnt(0)
v_cmp_eq_u32 vcc, 0, v17
s_cbranch_vccz L_h0_g_ok
s_sub_u32 s39, s39, 1
s_cbranch_scc1 L_timeout
ds_read_b64 v[16:17], v25 offset:2304
s_branch L_h0_g
L_h0_g_ok:
v_cvt_pk_bf16_f32 v28, v28, v28
v_and_b32 v28, 0xffff0000, v28
v_mul_f32 v28, v28, v16
v_cvt_pk_bf16_f32 v28, v28, v28
v_and_b32 v28, 0xffff0000, v28
v_add_f32 v28, v28, v20
v_cvt_pk_bf16_f32 v28, v28, v28
s_mov_b64 exec, 0xffff
buffer_store_short v28, v21, s[80:83], s42 offen
s_waitcnt lgkmcnt(0)
s_endpgm
L_H1:
s_cmp_ge_u32 s2, 192
s_cbranch_scc1 L_H1D
s_mul_i32 s41, s40, 3
s_lshr_b32 s4, s2, 6
s_add_u32 s41, s41, s4
s_cmp_ge_u32 s41, 22
s_cbranch_scc1 L_wexit
s_lshl_b32 s43, s42, 7
v_mul_u32_u24 v19, 2752, v2
v_and_b32 v24, 7, v3
v_lshl_add_u32 v19, v24, 4, v19
s_mul_i32 s4, s42, 176128
s_lshl_b32 s5, s41, 7
s_add_u32 s4, s4, s5
s_waitcnt lgkmcnt(0)
s_mov_b32 s52, s8
s_and_b32 s53, s9, 0xffff
s_mov_b32 s54, 0x800
s_mov_b32 s55, 0x20000
v_lshlrev_b32 v1, 4, v0
v_lshl_add_u32 v14, v3, 2, v2
v_lshlrev_b32 v14, 1, v14
buffer_load_dwordx4 v[4:7], v1, s[52:55], 0 offen
buffer_load_dwordx4 v[8:11], v1, s[52:55], 0 offen offset:1024
buffer_load_ushort v12, v14, s[52:55], s43 offen
buffer_load_ushort v13, v14, s[52:55], s43 offen offset:1024
s_load_dword s32, s[30:31], 0
s_mov_b32 s68, s20
s_and_b32 s69, s21, 0xffff
s_mov_b32 s70, 0x158000
s_mov_b32 s71, 0x20000
s_mov_b32 s72, s22
s_and_b32 s73, s23, 0xffff
s_mov_b32 s74, 0x158000
s_mov_b32 s75, 0x20000
s_mov_b32 s7, 0x00ff00ff
s_cmp_eq_u32 s41, 21
s_cselect_b32 s7, 0x000f000f, s7
s_mov_b32 s78, s7
s_mov_b32 s79, s7
s_lshl_b32 s80, s7, 8
s_lshl_b32 s81, s7, 8
v_mov_b32 v155, v19
s_mov_b32 s101, s4
s_add_u32 s82, s101, 0
s_mov_b64 exec, s[78:79]
buffer_load_dwordx4 v[32:35], v155, s[68:71], s82 offen nt
s_mov_b64 exec, s[80:81]
buffer_load_dwordx4 v[32:35], v155, s[72:75], s82 offen nt
s_mov_b64 exec, -1
s_add_u32 s83, s101, 11008
s_mov_b64 exec, s[78:79]
buffer_load_dwordx4 v[36:39], v155, s[68:71], s83 offen nt
s_mov_b64 exec, s[80:81]
buffer_load_dwordx4 v[36:39], v155, s[72:75], s83 offen nt
s_mov_b64 exec, -1
s_add_u32 s82, s101, 22016
s_mov_b64 exec, s[78:79]
buffer_load_dwordx4 v[40:43], v155, s[68:71], s82 offen nt
s_mov_b64 exec, s[80:81]
buffer_load_dwordx4 v[40:43], v155, s[72:75], s82 offen nt
s_mov_b64 exec, -1
s_add_u32 s83, s101, 33024
s_mov_b64 exec, s[78:79]
buffer_load_dwordx4 v[44:47], v155, s[68:71], s83 offen nt
s_mov_b64 exec, s[80:81]
buffer_load_dwordx4 v[44:47], v155, s[72:75], s83 offen nt
s_mov_b64 exec, -1
s_add_u32 s82, s101, 44032
s_mov_b64 exec, s[78:79]
buffer_load_dwordx4 v[48:51], v155, s[68:71], s82 offen nt
s_mov_b64 exec, s[80:81]
buffer_load_dwordx4 v[48:51], v155, s[72:75], s82 offen nt
s_mov_b64 exec, -1
s_add_u32 s83, s101, 55040
s_mov_b64 exec, s[78:79]
buffer_load_dwordx4 v[52:55], v155, s[68:71], s83 offen nt
s_mov_b64 exec, s[80:81]
buffer_load_dwordx4 v[52:55], v155, s[72:75], s83 offen nt
s_mov_b64 exec, -1
s_add_u32 s82, s101, 66048
s_mov_b64 exec, s[78:79]
buffer_load_dwordx4 v[56:59], v155, s[68:71], s82 offen nt
s_mov_b64 exec, s[80:81]
buffer_load_dwordx4 v[56:59], v155, s[72:75], s82 offen nt
s_mov_b64 exec, -1
s_add_u32 s83, s101, 77056
s_mov_b64 exec, s[78:79]
buffer_load_dwordx4 v[60:63], v155, s[68:71], s83 offen nt
s_mov_b64 exec, s[80:81]
buffer_load_dwordx4 v[60:63], v155, s[72:75], s83 offen nt
s_mov_b64 exec, -1
s_add_u32 s82, s101, 88064
s_mov_b64 exec, s[78:79]
buffer_load_dwordx4 v[64:67], v155, s[68:71], s82 offen nt
s_mov_b64 exec, s[80:81]
buffer_load_dwordx4 v[64:67], v155, s[72:75], s82 offen nt
s_mov_b64 exec, -1
s_add_u32 s83, s101, 99072
s_mov_b64 exec, s[78:79]
buffer_load_dwordx4 v[68:71], v155, s[68:71], s83 offen nt
s_mov_b64 exec, s[80:81]
buffer_load_dwordx4 v[68:71], v155, s[72:75], s83 offen nt
s_mov_b64 exec, -1
s_add_u32 s82, s101, 110080
s_mov_b64 exec, s[78:79]
buffer_load_dwordx4 v[72:75], v155, s[68:71], s82 offen nt
s_mov_b64 exec, s[80:81]
buffer_load_dwordx4 v[72:75], v155, s[72:75], s82 offen nt
s_mov_b64 exec, -1
s_add_u32 s83, s101, 121088
s_mov_b64 exec, s[78:79]
buffer_load_dwordx4 v[76:79], v155, s[68:71], s83 offen nt
s_mov_b64 exec, s[80:81]
buffer_load_dwordx4 v[76:79], v155, s[72:75], s83 offen nt
s_mov_b64 exec, -1
s_add_u32 s82, s101, 132096
s_mov_b64 exec, s[78:79]
buffer_load_dwordx4 v[80:83], v155, s[68:71], s82 offen nt
s_mov_b64 exec, s[80:81]
buffer_load_dwordx4 v[80:83], v155, s[72:75], s82 offen nt
s_mov_b64 exec, -1
s_add_u32 s83, s101, 143104
s_mov_b64 exec, s[78:79]
buffer_load_dwordx4 v[84:87], v155, s[68:71], s83 offen nt
s_mov_b64 exec, s[80:81]
buffer_load_dwordx4 v[84:87], v155, s[72:75], s83 offen nt
s_mov_b64 exec, -1
s_add_u32 s82, s101, 154112
s_mov_b64 exec, s[78:79]
buffer_load_dwordx4 v[88:91], v155, s[68:71], s82 offen nt
s_mov_b64 exec, s[80:81]
buffer_load_dwordx4 v[88:91], v155, s[72:75], s82 offen nt
s_mov_b64 exec, -1
s_add_u32 s83, s101, 165120
s_mov_b64 exec, s[78:79]
buffer_load_dwordx4 v[92:95], v155, s[68:71], s83 offen nt
s_mov_b64 exec, s[80:81]
buffer_load_dwordx4 v[92:95], v155, s[72:75], s83 offen nt
s_mov_b64 exec, -1
s_barrier
s_mov_b32 s64, s30
s_and_b32 s65, s31, 0xffff
s_mov_b32 s66, 0x130000
s_mov_b32 s67, 0x20000
v_and_b32 v24, 7, v3
v_and_b32 v25, 1, v24
v_lshlrev_b32 v25, 4, v25
v_mov_b32 v26, 0xffff
v_lshlrev_b32 v25, v25, v26
v_lshrrev_b32 v26, 1, v24
v_cmp_eq_u32 vcc, 0, v26
s_nop 1
v_cndmask_b32 v128, 0, v25, vcc
v_cmp_eq_u32 vcc, 1, v26
s_nop 1
v_cndmask_b32 v129, 0, v25, vcc
v_cmp_eq_u32 vcc, 2, v26
s_nop 1
v_cndmask_b32 v130, 0, v25, vcc
v_cmp_eq_u32 vcc, 3, v26
s_nop 1
v_cndmask_b32 v131, 0, v25, vcc
v_mov_b32 v26, 0xff
s_waitcnt vmcnt(32)
s_mov_b32 s4, 0x3f803f80
v_dot2_f32_bf16 v14, v4, s4, 0
v_dot2_f32_bf16 v15, v8, s4, 0
v_dot2_f32_bf16 v14, v5, s4, v14
v_dot2_f32_bf16 v15, v9, s4, v15
v_dot2_f32_bf16 v14, v6, s4, v14
v_dot2_f32_bf16 v15, v10, s4, v15
v_dot2_f32_bf16 v14, v7, s4, v14
v_dot2_f32_bf16 v15, v11, s4, v15
s_nop 1
v_add_f32_dpp v16, v14, v14 row_ror:8 row_mask:0xf bank_mask:0x3
s_nop 1
v_add_f32_dpp v16, v15, v15 row_ror:8 row_mask:0xf bank_mask:0xc
s_nop 1
v_add_f32_dpp v16, v16, v16 row_half_mirror row_mask:0xf bank_mask:0xf
s_nop 1
v_add_f32_dpp v16, v16, v16 quad_perm:[1,0,3,2] row_mask:0xf bank_mask:0xf
s_nop 1
v_add_f32_dpp v16, v16, v16 quad_perm:[2,3,0,1] row_mask:0xf bank_mask:0xf
v_mov_b32 v17, v16
s_nop 1
v_permlane16_swap_b32 v16, v17
v_add_f32 v16, v16, v17
v_mov_b32 v17, v16
s_nop 1
v_permlane32_swap_b32 v16, v17
v_add_f32 v16, v16, v17
v_mul_f32 v16, 0x3b000000, v16
s_nop 0
v_readlane_b32 s4, v16, 0
v_readlane_b32 s5, v16, 8
v_cvt_pk_bf16_f32 v18, v16, v16
v_and_b32 v18, 0xffff0000, v18
v_lshlrev_b32 v20, 16, v4
v_and_b32 v21, 0xffff0000, v4
v_subrev_f32 v20, s4, v20
v_subrev_f32 v21, s4, v21
v_mul_f32 v14, v20, v20
v_fmac_f32 v14, v21, v21
v_lshlrev_b32 v22, 16, v8
v_and_b32 v23, 0xffff0000, v8
v_subrev_f32 v22, s5, v22
v_subrev_f32 v23, s5, v23
v_mul_f32 v15, v22, v22
v_fmac_f32 v15, v23, v23
v_lshlrev_b32 v20, 16, v5
v_and_b32 v21, 0xffff0000, v5
v_subrev_f32 v20, s4, v20
v_subrev_f32 v21, s4, v21
v_fmac_f32 v14, v20, v20
v_fmac_f32 v14, v21, v21
v_lshlrev_b32 v22, 16, v9
v_and_b32 v23, 0xffff0000, v9
v_subrev_f32 v22, s5, v22
v_subrev_f32 v23, s5, v23
v_fmac_f32 v15, v22, v22
v_fmac_f32 v15, v23, v23
v_lshlrev_b32 v20, 16, v6
v_and_b32 v21, 0xffff0000, v6
v_subrev_f32 v20, s4, v20
v_subrev_f32 v21, s4, v21
v_fmac_f32 v14, v20, v20
v_fmac_f32 v14, v21, v21
v_lshlrev_b32 v22, 16, v10
v_and_b32 v23, 0xffff0000, v10
v_subrev_f32 v22, s5, v22
v_subrev_f32 v23, s5, v23
v_fmac_f32 v15, v22, v22
v_fmac_f32 v15, v23, v23
v_lshlrev_b32 v20, 16, v7
v_and_b32 v21, 0xffff0000, v7
v_subrev_f32 v20, s4, v20
v_subrev_f32 v21, s4, v21
v_fmac_f32 v14, v20, v20
v_fmac_f32 v14, v21, v21
v_lshlrev_b32 v22, 16, v11
v_and_b32 v23, 0xffff0000, v11
v_subrev_f32 v22, s5, v22
v_subrev_f32 v23, s5, v23
v_fmac_f32 v15, v22, v22
v_fmac_f32 v15, v23, v23
v_add_f32_dpp v16, v14, v14 row_ror:8 row_mask:0xf bank_mask:0x3
s_nop 1
v_add_f32_dpp v16, v15, v15 row_ror:8 row_mask:0xf bank_mask:0xc
s_nop 1
v_add_f32_dpp v16, v16, v16 row_half_mirror row_mask:0xf bank_mask:0xf
s_nop 1
v_add_f32_dpp v16, v16, v16 quad_perm:[1,0,3,2] row_mask:0xf bank_mask:0xf
s_nop 1
v_add_f32_dpp v16, v16, v16 quad_perm:[2,3,0,1] row_mask:0xf bank_mask:0xf
v_mov_b32 v17, v16
s_nop 1
v_permlane16_swap_b32 v16, v17
v_add_f32 v16, v16, v17
v_mov_b32 v17, v16
s_nop 1
v_permlane32_swap_b32 v16, v17
v_add_f32 v16, v16, v17
v_mul_f32 v16, 0x3b000000, v16
v_cvt_pk_bf16_f32 v16, v16, v16
v_and_b32 v16, 0xffff0000, v16
v_add_f32 v16, 0x3727c5ac, v16
v_cvt_pk_bf16_f32 v16, v16, v16
v_and_b32 v16, 0xffff0000, v16
v_sqrt_f32 v16, v16
s_nop 0
v_cvt_pk_bf16_f32 v16, v16, v16
v_and_b32 v16, 0xffff0000, v16
v_rcp_f32 v17, v16
v_readlane_b32 s4, v18, 0
v_readlane_b32 s5, v18, 8
v_readlane_b32 s6, v16, 0
v_readlane_b32 s7, v16, 8
v_readlane_b32 s38, v17, 0
v_readlane_b32 s40, v17, 8
v_lshlrev_b32 v12, 16, v12
v_subrev_f32 v12, s4, v12
v_cvt_pk_bf16_f32 v12, v12, v12
v_and_b32 v12, 0xffff0000, v12
v_mul_f32 v20, s38, v12
v_fma_f32 v21, -v20, s6, v12
v_fma_f32 v20, v21, s38, v20
v_cvt_pk_bf16_f32 v12, v20, v20
v_lshlrev_b32 v13, 16, v13
v_subrev_f32 v13, s5, v13
v_cvt_pk_bf16_f32 v13, v13, v13
v_and_b32 v13, 0xffff0000, v13
v_mul_f32 v22, s40, v13
v_fma_f32 v23, -v22, s7, v13
v_fma_f32 v22, v23, s40, v22
v_cvt_pk_bf16_f32 v13, v22, v22
v_lshlrev_b32 v14, 6, v2
v_lshl_add_u32 v15, v3, 2, v14
ds_write_b32 v15, v12 offset:3328
ds_write_b32 v15, v13 offset:3584
v_lshrrev_b32 v15, 3, v3
v_lshl_add_u32 v15, v15, 8, v14
ds_read_b128 v[96:99], v15 offset:3328
ds_read_b128 v[100:103], v15 offset:3344
ds_read_b128 v[104:107], v15 offset:3360
ds_read_b128 v[108:111], v15 offset:3376
v_lshrrev_b32 v152, 3, v3
v_lshl_add_u32 v152, v2, 1, v152
v_lshlrev_b32 v152, 4, v152
v_lshl_add_u32 v152, v24, 10, v152
s_waitcnt lgkmcnt(0)
s_add_u32 s32, s32, 0x10010101
s_and_b32 s33, s32, 0xff
s_bfe_u32 s34, s32, 0x80008
s_bfe_u32 s35, s32, 0x80010
s_lshr_b32 s36, s32, 24
s_getreg_b32 s100, hwreg(HW_REG_XCC_ID, 0, 4)
s_and_b32 s18, s36, 0xf0
s_or_b32 s100, s100, s18
s_and_b32 s37, s32, 0xffff
s_lshr_b32 s18, s32, 16
s_lshl_b32 s4, s41, 13
s_add_u32 s4, s4, 0x100000
s_add_u32 s76, s4, s43
s_lshl_b32 s5, s42, 10
s_add_u32 s77, s4, s5
v_and_b32 v112, v96, v128
v_and_b32 v113, v96, v129
v_and_b32 v114, v96, v130
v_and_b32 v115, v96, v131
v_and_b32 v116, v97, v128
v_and_b32 v117, v97, v129
v_and_b32 v118, v97, v130
v_and_b32 v119, v97, v131
s_waitcnt vmcnt(30)
v_mfma_f32_16x16x32_bf16 v[132:135], v[32:35], v[112:115], 0
v_and_b32 v120, v98, v128
v_and_b32 v121, v98, v129
v_and_b32 v122, v98, v130
v_and_b32 v123, v98, v131
s_waitcnt vmcnt(28)
v_mfma_f32_16x16x32_bf16 v[132:135], v[36:39], v[116:119], v[132:135]
v_and_b32 v124, v99, v128
v_and_b32 v125, v99, v129
v_and_b32 v126, v99, v130
v_and_b32 v127, v99, v131
s_waitcnt vmcnt(26)
v_mfma_f32_16x16x32_bf16 v[132:135], v[40:43], v[120:123], v[132:135]
v_and_b32 v112, v100, v128
v_and_b32 v113, v100, v129
v_and_b32 v114, v100, v130
v_and_b32 v115, v100, v131
s_waitcnt vmcnt(24)
v_mfma_f32_16x16x32_bf16 v[132:135], v[44:47], v[124:127], v[132:135]
v_and_b32 v116, v101, v128
v_and_b32 v117, v101, v129
v_and_b32 v118, v101, v130
v_and_b32 v119, v101, v131
s_waitcnt vmcnt(22)
v_mfma_f32_16x16x32_bf16 v[132:135], v[48:51], v[112:115], v[132:135]
v_and_b32 v120, v102, v128
v_and_b32 v121, v102, v129
v_and_b32 v122, v102, v130
v_and_b32 v123, v102, v131
s_waitcnt vmcnt(20)
v_mfma_f32_16x16x32_bf16 v[132:135], v[52:55], v[116:119], v[132:135]
v_and_b32 v124, v103, v128
v_and_b32 v125, v103, v129
v_and_b32 v126, v103, v130
v_and_b32 v127, v103, v131
s_waitcnt vmcnt(18)
v_mfma_f32_16x16x32_bf16 v[132:135], v[56:59], v[120:123], v[132:135]
v_and_b32 v112, v104, v128
v_and_b32 v113, v104, v129
v_and_b32 v114, v104, v130
v_and_b32 v115, v104, v131
s_waitcnt vmcnt(16)
v_mfma_f32_16x16x32_bf16 v[132:135], v[60:63], v[124:127], v[132:135]
v_and_b32 v116, v105, v128
v_and_b32 v117, v105, v129
v_and_b32 v118, v105, v130
v_and_b32 v119, v105, v131
s_waitcnt vmcnt(14)
v_mfma_f32_16x16x32_bf16 v[132:135], v[64:67], v[112:115], v[132:135]
v_and_b32 v120, v106, v128
v_and_b32 v121, v106, v129
v_and_b32 v122, v106, v130
v_and_b32 v123, v106, v131
s_waitcnt vmcnt(12)
v_mfma_f32_16x16x32_bf16 v[132:135], v[68:71], v[116:119], v[132:135]
v_and_b32 v124, v107, v128
v_and_b32 v125, v107, v129
v_and_b32 v126, v107, v130
v_and_b32 v127, v107, v131
s_waitcnt vmcnt(10)
v_mfma_f32_16x16x32_bf16 v[132:135], v[72:75], v[120:123], v[132:135]
v_and_b32 v112, v108, v128
v_and_b32 v113, v108, v129
v_and_b32 v114, v108, v130
v_and_b32 v115, v108, v131
s_waitcnt vmcnt(8)
v_mfma_f32_16x16x32_bf16 v[132:135], v[76:79], v[124:127], v[132:135]
v_and_b32 v116, v109, v128
v_and_b32 v117, v109, v129
v_and_b32 v118, v109, v130
v_and_b32 v119, v109, v131
s_waitcnt vmcnt(6)
v_mfma_f32_16x16x32_bf16 v[132:135], v[80:83], v[112:115], v[132:135]
v_and_b32 v120, v110, v128
v_and_b32 v121, v110, v129
v_and_b32 v122, v110, v130
v_and_b32 v123, v110, v131
s_waitcnt vmcnt(4)
v_mfma_f32_16x16x32_bf16 v[132:135], v[84:87], v[116:119], v[132:135]
v_and_b32 v124, v111, v128
v_and_b32 v125, v111, v129
v_and_b32 v126, v111, v130
v_and_b32 v127, v111, v131
s_waitcnt vmcnt(2)
v_mfma_f32_16x16x32_bf16 v[132:135], v[88:91], v[120:123], v[132:135]
s_waitcnt vmcnt(0)
v_mfma_f32_16x16x32_bf16 v[132:135], v[92:95], v[124:127], v[132:135]
s_nop 7
v_bfi_b32 v132, v26, s33, v132
v_bfi_b32 v133, v26, s34, v133
v_bfi_b32 v134, v26, s35, v134
v_bfi_b32 v135, v26, s100, v135
buffer_store_dwordx4 v[132:135], v152, s[64:67], s76 offen
s_lshl_b32 s7, s41, 9
s_lshl_b32 s5, s42, 6
s_add_u32 s7, s7, s5
s_add_u32 s7, s7, 0x8000
v_and_b32 v21, 1, v0
v_lshlrev_b32 v21, 3, v21
v_lshl_add_u32 v21, v2, 4, v21
v_bfe_u32 v17, v0, 1, 1
v_lshl_add_u32 v21, v17, 2, v21
s_mov_b32 s43, 0x000f000f
s_cmp_eq_u32 s41, 21
s_cselect_b32 s43, 0x00030003, s43
v_mov_b32 v22, s37
v_lshlrev_b32 v23, 3, v24
L_h1_fg:
ds_read_b32 v14, v23 offset:2432
s_waitcnt lgkmcnt(0)
v_cmp_ne_u32 vcc, 0, v14
s_bcnt1_i32_b64 s40, vcc
s_cmp_ge_u32 s40, 64
s_cbranch_scc1 L_h1_fg_ok
s_sub_u32 s39, s39, 1
s_cbranch_scc1 L_timeout
s_branch L_h1_fg
L_h1_fg_ok:
buffer_load_dwordx4 v[136:139], v1, s[64:67], s77 offen sc1
s_waitcnt vmcnt(0)
v_xor_b32 v136, s33, v136
v_xor_b32 v137, s34, v137
v_xor_b32 v138, s35, v138
v_xor_b32 v139, s100, v139
v_or3_b32 v14, v136, v137, v138
v_or_b32 v14, v14, v139
v_and_b32 v14, 0xff, v14
v_cmp_ne_u32 vcc, 0, v14
s_cbranch_vccz L_h1_gu_ok
buffer_store_dwordx4 v[132:135], v152, s[64:67], s76 offen sc1
s_mov_b32 s78, 1
L_h1_gu:
s_sub_u32 s39, s39, 1
s_cbranch_scc1 L_timeout
buffer_load_dwordx4 v[136:139], v1, s[64:67], s77 offen sc1
s_waitcnt vmcnt(0)
v_xor_b32 v136, s33, v136
v_xor_b32 v137, s34, v137
v_xor_b32 v138, s35, v138
v_xor_b32 v139, s100, v139
v_and_b32 v14, 0xf0, v139
v_or3_b32 v14, v14, v136, v137
v_or_b32 v14, v14, v138
v_and_b32 v14, 0xff, v14
v_cmp_ne_u32 vcc, 0, v14
s_cbranch_vccnz L_h1_gu
L_h1_gu_ok:
v_permlane32_swap_b32 v136, v138
v_permlane32_swap_b32 v137, v139
v_add_f32 v136, v136, v138
v_add_f32 v137, v137, v139
s_nop 1
v_permlane16_swap_b32 v136, v137
v_add_f32 v136, v136, v137
s_nop 1
v_add_f32_dpp v136, v136, v136 row_ror:8 row_mask:0xf bank_mask:0xf
v_cvt_pk_bf16_f32 v136, v136, v136
v_and_b32 v136, 0xffff0000, v136
s_nop 1
v_mov_b32_dpp v137, v136 row_ror:4 row_mask:0xf bank_mask:0xf
v_mul_f32 v12, 0xbfb8aa3b, v136
v_exp_f32 v12, v12
s_nop 0
v_add_f32 v12, 1.0, v12
v_rcp_f32 v13, v12
s_nop 0
v_mul_f32 v14, v136, v13
v_fma_f32 v15, -v14, v12, v136
v_fma_f32 v15, v15, v13, v14
v_cmp_class_f32 vcc, v15, 3
s_nop 1
v_cndmask_b32 v16, v15, v14, vcc
v_cvt_pk_bf16_f32 v16, v16, v16
v_and_b32 v16, 0xffff0000, v16
v_mul_f32 v16, v16, v137
v_cvt_pk_bf16_f32 v16, v16, v16
v_and_b32 v16, 0xffff0000, v16
s_mov_b32 exec_lo, s43
s_mov_b32 exec_hi, s43
v_or_b32 v22, v22, v16
s_mov_b32 exec_lo, 0x000f000f
s_mov_b32 exec_hi, 0x000f000f
buffer_store_dword v22, v21, s[64:67], s7 offen sc1
s_waitcnt lgkmcnt(0)
s_endpgm
L_H1D:
s_barrier
s_and_b32 s38, s42, 3
s_lshr_b32 s41, s42, 2
s_mul_i32 s4, s40, 192
s_lshl_b32 s5, s41, 2
s_add_u32 s4, s4, s5
s_lshl_b32 s4, s4, 10
s_lshl_b32 s5, s38, 8
s_add_u32 s4, s4, s5
v_lshlrev_b32 v19, 13, v2
v_lshl_add_u32 v19, v3, 4, v19
s_waitcnt lgkmcnt(0)
s_load_dword s32, s[30:31], 0
s_mov_b32 s64, s30
s_and_b32 s65, s31, 0xffff
s_mov_b32 s66, 0x130000
s_mov_b32 s67, 0x20000
v_lshlrev_b32 v20, 13, v2
v_lshl_add_u32 v20, v3, 3, v20
s_sub_u32 s43, s2, 192
s_lshl_b32 s5, s43, 7
s_add_u32 s5, s5, 0x10000
v_mov_b32 v4, 0
v_mov_b32 v5, 0
buffer_atomic_swap_x2 v[4:5], v20, s[64:67], s5 offen sc0 sc1
s_lshl_b32 s5, s43, 2
s_add_u32 s5, s5, 0x2000
v_mov_b32 v6, 0
s_mov_b32 s68, s5
s_waitcnt vmcnt(0)
s_waitcnt lgkmcnt(0)
s_add_u32 s6, s32, 0x10010101
v_mov_b32 v7, s6
s_mov_b64 exec, 1
buffer_store_dword v7, v6, s[64:67], s68 offen sc1
s_mov_b64 exec, -1
s_mov_b32 s76, s24
s_and_b32 s77, s25, 0xffff
s_mov_b32 s78, 0x158000
s_mov_b32 s79, 0x20000
s_add_u32 s5, s4, 0
buffer_load_dwordx4 v[32:35], v19, s[76:79], s5 offen nt
s_add_u32 s6, s4, 1024
buffer_load_dwordx4 v[40:43], v19, s[76:79], s6 offen nt
s_add_u32 s5, s4, 2048
buffer_load_dwordx4 v[48:51], v19, s[76:79], s5 offen nt
s_add_u32 s6, s4, 3072
buffer_load_dwordx4 v[56:59], v19, s[76:79], s6 offen nt
s_cmp_eq_u32 s40, 7
s_cbranch_scc1 L_h1d_ld
s_add_u32 s5, s4, 32768
buffer_load_dwordx4 v[36:39], v19, s[76:79], s5 offen nt
s_add_u32 s6, s4, 33792
buffer_load_dwordx4 v[44:47], v19, s[76:79], s6 offen nt
s_add_u32 s5, s4, 34816
buffer_load_dwordx4 v[52:55], v19, s[76:79], s5 offen nt
s_add_u32 s6, s4, 35840
buffer_load_dwordx4 v[60:63], v19, s[76:79], s6 offen nt
s_add_u32 s5, s4, 65536
buffer_load_dwordx4 v[64:67], v19, s[76:79], s5 offen nt
s_add_u32 s6, s4, 98304
buffer_load_dwordx4 v[68:71], v19, s[76:79], s6 offen nt
s_add_u32 s5, s4, 66560
buffer_load_dwordx4 v[72:75], v19, s[76:79], s5 offen nt
s_add_u32 s6, s4, 99328
buffer_load_dwordx4 v[76:79], v19, s[76:79], s6 offen nt
s_add_u32 s5, s4, 67584
buffer_load_dwordx4 v[80:83], v19, s[76:79], s5 offen nt
s_add_u32 s6, s4, 100352
buffer_load_dwordx4 v[84:87], v19, s[76:79], s6 offen nt
s_add_u32 s5, s4, 68608
buffer_load_dwordx4 v[88:91], v19, s[76:79], s5 offen nt
s_add_u32 s6, s4, 101376
buffer_load_dwordx4 v[92:95], v19, s[76:79], s6 offen nt
s_add_u32 s5, s4, 131072
buffer_load_dwordx4 v[96:99], v19, s[76:79], s5 offen nt
s_add_u32 s6, s4, 163840
buffer_load_dwordx4 v[100:103], v19, s[76:79], s6 offen nt
s_add_u32 s5, s4, 132096
buffer_load_dwordx4 v[104:107], v19, s[76:79], s5 offen nt
s_add_u32 s6, s4, 164864
buffer_load_dwordx4 v[108:111], v19, s[76:79], s6 offen nt
s_add_u32 s5, s4, 133120
buffer_load_dwordx4 v[112:115], v19, s[76:79], s5 offen nt
s_add_u32 s6, s4, 165888
buffer_load_dwordx4 v[116:119], v19, s[76:79], s6 offen nt
s_add_u32 s5, s4, 134144
buffer_load_dwordx4 v[120:123], v19, s[76:79], s5 offen nt
s_add_u32 s6, s4, 166912
buffer_load_dwordx4 v[124:127], v19, s[76:79], s6 offen nt
L_h1d_ld:
s_mov_b32 s64, s30
s_and_b32 s65, s31, 0xffff
s_mov_b32 s66, 0x130000
s_mov_b32 s67, 0x20000
v_and_b32 v24, 7, v3
v_and_b32 v25, 1, v24
v_lshlrev_b32 v25, 4, v25
v_mov_b32 v26, 0xffff
v_lshlrev_b32 v25, v25, v26
v_lshrrev_b32 v26, 1, v24
v_cmp_eq_u32 vcc, 0, v26
s_nop 1
v_cndmask_b32 v8, 0, v25, vcc
v_cmp_eq_u32 vcc, 1, v26
s_nop 1
v_cndmask_b32 v9, 0, v25, vcc
v_cmp_eq_u32 vcc, 2, v26
s_nop 1
v_cndmask_b32 v10, 0, v25, vcc
v_cmp_eq_u32 vcc, 3, v26
s_nop 1
v_cndmask_b32 v11, 0, v25, vcc
v_mov_b32 v26, 0xff
v_lshlrev_b32 v1, 4, v0
s_mul_i32 s4, s40, 1536
s_lshl_b32 s5, s41, 8
s_add_u32 s4, s4, s5
s_add_u32 s68, s4, 0x8000
v_lshlrev_b32 v20, 9, v2
v_lshl_add_u32 v20, v3, 4, v20
s_cmp_eq_u32 s40, 7
s_cselect_b32 s70, 0xffff, -1
s_cselect_b32 s71, 0, 0xffff
s_mov_b32 s69, 0x03020302
v_lshrrev_b32 v21, 3, v3
v_lshlrev_b32 v21, 3, v21
v_lshl_add_u32 v21, v2, 4, v21
s_lshl_b32 s7, s40, 1
s_add_u32 s7, s7, s41
s_lshl_b32 s7, s7, 12
s_lshl_b32 s5, s38, 10
s_add_u32 s7, s7, s5
s_add_u32 s7, s7, 0x90000
s_sub_u32 s43, s2, 192
s_bfe_u32 s5, s43, 0x10005
s_bfe_u32 s6, s43, 0x40001
s_lshl_b32 s6, s6, 8
s_lshl_b32 s5, s5, 7
s_add_u32 s6, s6, s5
s_and_b32 s5, s43, 1
s_lshl_b32 s5, s5, 6
s_add_u32 s6, s6, s5
s_add_u32 s6, s6, 0x90000
v_and_b32 v22, 3, v0
v_lshrrev_b32 v23, 2, v0
v_lshlrev_b32 v23, 12, v23
v_lshl_add_u32 v23, v22, 4, v23
v_lshl_add_u32 v25, v2, 2, v22
v_lshlrev_b32 v25, 3, v25
s_mov_b64 s[44:45], -1
v_mov_b32 v28, 0
v_mov_b32 v16, 0
v_mov_b32 v29, 0
v_mov_b32 v17, 0
v_mov_b32 v30, 0
v_mov_b32 v18, 0
v_mov_b32 v31, 0
v_mov_b32 v19, 0
s_waitcnt lgkmcnt(0)
s_add_u32 s32, s32, 0x10010101
s_and_b32 s33, s32, 0xff
s_bfe_u32 s34, s32, 0x80008
s_bfe_u32 s35, s32, 0x80010
s_lshr_b32 s36, s32, 24
s_getreg_b32 s100, hwreg(HW_REG_XCC_ID, 0, 4)
s_and_b32 s18, s36, 0xf0
s_or_b32 s100, s100, s18
s_and_b32 s37, s32, 0xffff
s_lshr_b32 s18, s32, 16
v_lshlrev_b32 v27, 3, v24
v_mov_b32 v14, 0
L_h1d_q:
ds_read_b32 v15, v14 offset:2496
s_waitcnt lgkmcnt(0)
v_cmp_eq_u32 vcc, 0, v15
s_cbranch_vccz L_h1d_q_ok
s_sub_u32 s39, s39, 1
s_cbranch_scc1 L_timeout
s_branch L_h1d_q
L_h1d_q_ok:
s_mov_b64 exec, s[70:71]
L_h1_h:
buffer_load_dwordx4 v[16:19], v20, s[64:67], s68 offen sc1
s_waitcnt vmcnt(0)
v_xor_b32 v16, s37, v16
v_xor_b32 v17, s37, v17
v_xor_b32 v18, s37, v18
v_xor_b32 v19, s37, v19
v_or3_b32 v14, v16, v17, v18
v_or_b32 v14, v14, v19
v_and_b32 v14, 0xffff, v14
v_cmp_ne_u32 vcc, 0, v14
s_cbranch_vccz L_h1_h_ok
s_sub_u32 s39, s39, 1
s_cbranch_scc1 L_timeout
s_branch L_h1_h
L_h1_h_ok:
s_mov_b64 exec, -1
v_perm_b32 v16, v16, v16, s69
v_perm_b32 v17, v17, v17, s69
v_perm_b32 v18, v18, v18, s69
v_perm_b32 v19, v19, v19, s69
s_mov_b32 exec_hi, 0xffff
ds_write_b128 v1, v[16:19] offset:2560
s_mov_b64 exec, -1
ds_read_b64 v[128:129], v21 offset:2560
ds_read_b64 v[130:131], v21 offset:2624
ds_read_b64 v[132:133], v21 offset:2688
ds_read_b64 v[134:135], v21 offset:2752
ds_read_b64 v[136:137], v21 offset:2816
ds_read_b64 v[138:139], v21 offset:2880
ds_read_b64 v[140:141], v21 offset:2944
ds_read_b64 v[142:143], v21 offset:3008
ds_read_b64 v[144:145], v21 offset:3072
ds_read_b64 v[146:147], v21 offset:3136
ds_read_b64 v[148:149], v21 offset:3200
ds_read_b64 v[150:151], v21 offset:3264
s_waitcnt lgkmcnt(0)
s_cmp_eq_u32 s40, 7
v_and_b32 v152, v128, v8
v_and_b32 v153, v128, v9
v_and_b32 v154, v128, v10
v_and_b32 v155, v128, v11
v_and_b32 v156, v130, v8
v_and_b32 v157, v130, v9
v_and_b32 v158, v130, v10
v_and_b32 v159, v130, v11
v_mfma_f32_16x16x32_bf16 v[12:15], v[32:35], v[152:155], 0
v_and_b32 v160, v132, v8
v_and_b32 v161, v132, v9
v_and_b32 v162, v132, v10
v_and_b32 v163, v132, v11
v_mfma_f32_16x16x32_bf16 v[12:15], v[40:43], v[156:159], v[12:15]
v_and_b32 v164, v134, v8
v_and_b32 v165, v134, v9
v_and_b32 v166, v134, v10
v_and_b32 v167, v134, v11
v_mfma_f32_16x16x32_bf16 v[12:15], v[48:51], v[160:163], v[12:15]
v_and_b32 v152, v129, v8
v_and_b32 v153, v129, v9
v_and_b32 v154, v129, v10
v_and_b32 v155, v129, v11
v_mfma_f32_16x16x32_bf16 v[12:15], v[56:59], v[164:167], v[12:15]
v_and_b32 v156, v131, v8
v_and_b32 v157, v131, v9
v_and_b32 v158, v131, v10
v_and_b32 v159, v131, v11
s_cbranch_scc1 L_h1d_mm
v_mfma_f32_16x16x32_bf16 v[12:15], v[36:39], v[152:155], v[12:15]
v_and_b32 v160, v133, v8
v_and_b32 v161, v133, v9
v_and_b32 v162, v133, v10
v_and_b32 v163, v133, v11
v_mfma_f32_16x16x32_bf16 v[12:15], v[44:47], v[156:159], v[12:15]
v_and_b32 v164, v135, v8
v_and_b32 v165, v135, v9
v_and_b32 v166, v135, v10
v_and_b32 v167, v135, v11
v_mfma_f32_16x16x32_bf16 v[12:15], v[52:55], v[160:163], v[12:15]
v_and_b32 v152, v136, v8
v_and_b32 v153, v136, v9
v_and_b32 v154, v136, v10
v_and_b32 v155, v136, v11
v_mfma_f32_16x16x32_bf16 v[12:15], v[60:63], v[164:167], v[12:15]
v_and_b32 v156, v137, v8
v_and_b32 v157, v137, v9
v_and_b32 v158, v137, v10
v_and_b32 v159, v137, v11
v_mfma_f32_16x16x32_bf16 v[12:15], v[64:67], v[152:155], v[12:15]
v_and_b32 v160, v138, v8
v_and_b32 v161, v138, v9
v_and_b32 v162, v138, v10
v_and_b32 v163, v138, v11
v_mfma_f32_16x16x32_bf16 v[12:15], v[68:71], v[156:159], v[12:15]
v_and_b32 v164, v139, v8
v_and_b32 v165, v139, v9
v_and_b32 v166, v139, v10
v_and_b32 v167, v139, v11
v_mfma_f32_16x16x32_bf16 v[12:15], v[72:75], v[160:163], v[12:15]
v_and_b32 v152, v140, v8
v_and_b32 v153, v140, v9
v_and_b32 v154, v140, v10
v_and_b32 v155, v140, v11
v_mfma_f32_16x16x32_bf16 v[12:15], v[76:79], v[164:167], v[12:15]
v_and_b32 v156, v141, v8
v_and_b32 v157, v141, v9
v_and_b32 v158, v141, v10
v_and_b32 v159, v141, v11
v_mfma_f32_16x16x32_bf16 v[12:15], v[80:83], v[152:155], v[12:15]
v_and_b32 v160, v142, v8
v_and_b32 v161, v142, v9
v_and_b32 v162, v142, v10
v_and_b32 v163, v142, v11
v_mfma_f32_16x16x32_bf16 v[12:15], v[84:87], v[156:159], v[12:15]
v_and_b32 v164, v143, v8
v_and_b32 v165, v143, v9
v_and_b32 v166, v143, v10
v_and_b32 v167, v143, v11
v_mfma_f32_16x16x32_bf16 v[12:15], v[88:91], v[160:163], v[12:15]
v_and_b32 v152, v144, v8
v_and_b32 v153, v144, v9
v_and_b32 v154, v144, v10
v_and_b32 v155, v144, v11
v_mfma_f32_16x16x32_bf16 v[12:15], v[92:95], v[164:167], v[12:15]
v_and_b32 v156, v145, v8
v_and_b32 v157, v145, v9
v_and_b32 v158, v145, v10
v_and_b32 v159, v145, v11
v_mfma_f32_16x16x32_bf16 v[12:15], v[96:99], v[152:155], v[12:15]
v_and_b32 v160, v146, v8
v_and_b32 v161, v146, v9
v_and_b32 v162, v146, v10
v_and_b32 v163, v146, v11
v_mfma_f32_16x16x32_bf16 v[12:15], v[100:103], v[156:159], v[12:15]
v_and_b32 v164, v147, v8
v_and_b32 v165, v147, v9
v_and_b32 v166, v147, v10
v_and_b32 v167, v147, v11
v_mfma_f32_16x16x32_bf16 v[12:15], v[104:107], v[160:163], v[12:15]
v_and_b32 v152, v148, v8
v_and_b32 v153, v148, v9
v_and_b32 v154, v148, v10
v_and_b32 v155, v148, v11
v_mfma_f32_16x16x32_bf16 v[12:15], v[108:111], v[164:167], v[12:15]
v_and_b32 v156, v149, v8
v_and_b32 v157, v149, v9
v_and_b32 v158, v149, v10
v_and_b32 v159, v149, v11
v_mfma_f32_16x16x32_bf16 v[12:15], v[112:115], v[152:155], v[12:15]
v_and_b32 v160, v150, v8
v_and_b32 v161, v150, v9
v_and_b32 v162, v150, v10
v_and_b32 v163, v150, v11
v_mfma_f32_16x16x32_bf16 v[12:15], v[116:119], v[156:159], v[12:15]
v_and_b32 v164, v151, v8
v_and_b32 v165, v151, v9
v_and_b32 v166, v151, v10
v_and_b32 v167, v151, v11
v_mfma_f32_16x16x32_bf16 v[12:15], v[120:123], v[160:163], v[12:15]
s_nop 0
v_mfma_f32_16x16x32_bf16 v[12:15], v[124:127], v[164:167], v[12:15]
L_h1d_mm:
s_nop 7
v_bfi_b32 v12, v26, s33, v12
v_bfi_b32 v13, v26, s34, v13
v_bfi_b32 v14, v26, s35, v14
v_bfi_b32 v15, v26, s36, v15
L_h1d_p:
ds_read_b32 v18, v27 offset:2180
s_waitcnt lgkmcnt(0)
v_cmp_eq_u32 vcc, 0, v18
s_cbranch_vccz L_h1d_p_ok
s_sub_u32 s39, s39, 1
s_cbranch_scc1 L_timeout
s_branch L_h1d_p
L_h1d_p_ok:
buffer_store_dwordx4 v[12:15], v1, s[64:67], s7 offen sc1
v_mov_b32 v17, 1
s_barrier
buffer_load_dwordx4 v[32:35], v23, s[64:67], s6 offen sc1
L_h1_z:
s_mov_b32 s40, 0
s_waitcnt vmcnt(0)
s_cmp_eq_u64 s[44:45], 0
s_cbranch_scc1 L_h1_z0
s_mov_b64 exec, s[44:45]
v_xor_b32 v32, s33, v32
v_xor_b32 v33, s34, v33
v_xor_b32 v34, s35, v34
v_xor_b32 v35, s36, v35
v_or3_b32 v14, v32, v33, v34
v_or_b32 v14, v14, v35
v_and_b32 v14, 0xff, v14
v_cmp_eq_u32 vcc, 0, v14
s_andn2_b64 s[44:45], s[44:45], vcc
s_mov_b64 exec, vcc
v_add_f32 v28, v28, v32
v_add_f32 v29, v29, v33
v_add_f32 v30, v30, v34
v_add_f32 v31, v31, v35
s_cbranch_scc0 L_h1_z0
s_mov_b64 exec, s[44:45]
buffer_load_dwordx4 v[32:35], v23, s[64:67], s6 offen sc1
s_mov_b32 s40, 1
L_h1_z0:
s_mov_b64 exec, -1
s_cmp_eq_u32 s40, 0
s_cbranch_scc1 L_h1_z_ok
s_sub_u32 s39, s39, 1
s_cbranch_scc1 L_timeout
s_branch L_h1_z
L_h1_z_ok:
v_permlane32_swap_b32 v28, v30
v_permlane32_swap_b32 v29, v31
v_add_f32 v28, v28, v30
v_add_f32 v29, v29, v31
s_nop 1
v_permlane16_swap_b32 v28, v29
v_add_f32 v28, v28, v29
s_nop 1
v_add_f32_dpp v28, v28, v28 row_ror:4 row_mask:0xf bank_mask:0xf
s_nop 1
v_add_f32_dpp v28, v28, v28 row_ror:8 row_mask:0xf bank_mask:0xf
v_cvt_pk_bf16_f32 v28, v28, v28
v_and_b32 v28, 0xffff0000, v28
v_mul_f32 v12, 0xbfb8aa3b, v28
v_exp_f32 v12, v12
s_nop 0
v_add_f32 v12, 1.0, v12
v_rcp_f32 v13, v12
s_nop 0
v_mul_f32 v14, v28, v13
v_fma_f32 v15, -v14, v12, v28
v_fma_f32 v15, v15, v13, v14
v_cmp_class_f32 vcc, v15, 3
s_nop 1
v_cndmask_b32 v16, v15, v14, vcc
v_cvt_pk_bf16_f32 v16, v16, v16
v_and_b32 v16, 0xffff0000, v16
ds_write_b64 v25, v[16:17] offset:2304
s_cmp_lg_u32 s2, 192
s_cbranch_scc1 L_h1_end
s_mov_b32 s4, 0x3000
L_h1_e:
buffer_load_dwordx4 v[32:35], v1, s[64:67], s4 offen offset:0 sc1
buffer_load_dwordx4 v[36:39], v1, s[64:67], s4 offen offset:1024 sc1
buffer_load_dwordx4 v[40:43], v1, s[64:67], s4 offen offset:2048 sc1
buffer_load_dwordx4 v[44:47], v1, s[64:67], s4 offen offset:3072 sc1
s_waitcnt vmcnt(0)
v_xor_b32 v32, s37, v32
v_xor_b32 v34, s18, v34
v_xor_b32 v36, s37, v36
v_xor_b32 v38, s18, v38
v_xor_b32 v40, s37, v40
v_xor_b32 v42, s18, v42
v_xor_b32 v44, s37, v44
v_xor_b32 v46, s18, v46
v_or3_b32 v15, v32, v34, v36
v_or3_b32 v15, v15, v38, v40
v_or3_b32 v15, v15, v42, v44
v_or_b32 v15, v15, v46
v_and_b32 v15, 0xffff, v15
v_cmp_ne_u32 vcc, 0, v15
s_cbranch_vccz L_h1_e_ok
s_sub_u32 s39, s39, 1
s_cbranch_scc1 L_timeout
s_branch L_h1_e
L_h1_e_ok:
s_mov_b64 exec, 1
v_mov_b32 v16, s32
buffer_store_dword v16, v1, s[64:67], 0 offen sc1
L_h1_end:
s_waitcnt lgkmcnt(0)
s_endpgm
L_timeout:
s_waitcnt vmcnt(0)
L_wexit:
s_waitcnt lgkmcnt(0)
L_exit:
s_endpgm

.section .rodata,"a"
.p2align 6
.amdhsa_kernel recurrent_scan__sliding_block_cached__swiglu_ffn__decode_kernel
  .amdhsa_next_free_vgpr 168
  .amdhsa_next_free_sgpr 102
  .amdhsa_accum_offset 168
  .amdhsa_group_segment_fixed_size 0
  .amdhsa_kernarg_size 96
  .amdhsa_user_sgpr_count 2
  .amdhsa_user_sgpr_kernarg_segment_ptr 1
  .amdhsa_system_sgpr_workgroup_id_x 1
  .amdhsa_float_denorm_mode_32 3
.end_amdhsa_kernel
```
